```python
import torch

def _softmax(x, axis=-1):
    return torch.softmax(x, dim=axis)
def _gelu(x):
    return torch.nn.functional.gelu(x, approximate="tanh")
def _silu(x):
    return torch.nn.functional.silu(x)
def _sigmoid(x):
    return torch.sigmoid(x)
def _layernorm(x, axis=-1, eps=1e-5):
    m = x.mean(dim=axis, keepdim=True)
    v = x.var(dim=axis, keepdim=True, unbiased=False)
    return (x - m) / torch.sqrt(v + eps)
def _scatter_add(tgt, idx, src, axis=0):
    return tgt.clone().index_add_(axis, idx, src)
def _segment_sum(src, seg, n):
    out = torch.zeros((n,) + src.shape[1:], dtype=src.dtype)
    return out.index_add_(0, seg, src)
def _pad(x, pw):
    flat = tuple(v for pair in reversed(pw) for v in pair)
    return torch.nn.functional.pad(x, flat)

kernel_name = 'standalone__gqa_softmax__near_ridge'

def setup_inputs():

    _w = (lambda a: (lambda t: t.to(torch.bfloat16) if t.is_floating_point() else t)(torch.as_tensor(a)))
    B, Hq, Hkv, Sq, Sk, D = 8, 32, 16, 256, 1024, 128
    return {
        "q": _w((lambda *s: torch.randn(*s, dtype=torch.bfloat16) * 0.8)(B, Hq, Sq, D)),
        "k": _w((lambda *s: torch.randn(*s, dtype=torch.bfloat16) * 0.8)(B, Hkv, Sk, D)),
        "v": _w((lambda *s: torch.randn(*s, dtype=torch.bfloat16) * 0.05)(B, Hkv, Sk, D)),
    }

def reference(q, k, v):
    B, Hq, Sq, D = q.shape
    Hkv = k.shape[1]
    rep = Hq // Hkv
    k = (lambda x, n, axis: torch.repeat_interleave(x, n, dim=axis))(k, rep, axis=1)
    v = (lambda x, n, axis: torch.repeat_interleave(x, n, dim=axis))(v, rep, axis=1)
    scale = D ** -0.5
    scores = torch.einsum("bhqd,bhkd->bhqk", q, k) * scale
    p = _softmax(scores, axis=-1)
    return torch.einsum("bhqk,bhkd->bhqd", p, v)
```

```asm
; @launch grid=(256,1,1) block=(256,1,1) lds=163840
.amdgcn_target "amdgcn-amd-amdhsa--gfx950"
.text
.globl standalone__gqa_softmax__near_ridge_kernel
.p2align 8
.type standalone__gqa_softmax__near_ridge_kernel,@function
standalone__gqa_softmax__near_ridge_kernel:
    s_load_dwordx8 s[88:95], s[0:1], 0
    s_cmp_ge_u32 s2, 256
    s_cbranch_scc1 L_done
    s_getpc_b64 s[34:35]
L_pc:
    v_lshlrev_b32 v4, 4, v0
    s_bitcmp1_b32 s2, 3
    s_cselect_b32 s3, L_role1 - L_pc, 0
    v_add_u32 v4, s3, v4
    v_add_co_u32 v8, vcc, s34, v4
    v_mov_b32 v9, s35
    v_lshrrev_b32 v2, 6, v0
    v_addc_co_u32 v9, vcc, 0, v9, vcc
    global_load_dwordx4 v[200:203], v[8:9], off
    v_bfe_u32 v5, v0, 4, 2
    v_readfirstlane_b32 s20, v2
    v_and_b32 v6, 15, v0
    v_lshlrev_b32 v7, 8, v5
    v_lshl_add_u32 v7, v2, 12, v7
    v_xor_b32 v3, v6, v5
    v_lshl_add_u32 v228, v3, 4, v7
    v_xor_b32 v229, 64, v228
    v_xor_b32 v230, 128, v228
    v_xor_b32 v231, 192, v228
    s_and_b32 s30, s2, 7
    s_lshr_b32 s3, s2, 4
    s_lshl4_add_u32 s30, s30, s3
    s_bfe_u32 s31, s2, 0x10003
    s_lshl1_add_u32 s31, s30, s31
    s_lshl_b32 s30, s30, 18
    s_lshl_b32 s31, s31, 16
    s_lshl_b32 s21, s20, 12
    s_mul_i32 s84, s20, 12288
    s_lshl2_add_u32 s33, s21, 0xc000
    s_mov_b32 s23, 0
    s_mov_b32 s10, 0x40000
    s_mov_b32 s11, 0x20000
    s_mov_b32 s6, 0x10000
    s_mov_b32 s7, 0x20000
    s_mov_b32 m0, s21
    s_waitcnt lgkmcnt(0)
    s_add_u32 s8, s90, s30
    s_addc_u32 s9, s91, 0
    buffer_load_dwordx4 v228, s[8:11], s23 offen offset:0 lds
    buffer_load_dwordx4 v229, s[8:11], s23 offen offset:1024 lds
    buffer_load_dwordx4 v230, s[8:11], s23 offen offset:2048 lds
    buffer_load_dwordx4 v231, s[8:11], s23 offen offset:3072 lds
    s_add_u32 s4, s88, s31
    s_addc_u32 s5, s89, 0
    s_add_u32 m0, s33, 0
    s_add_u32 s28, s84, 0
    buffer_load_dwordx4 v228, s[4:7], s28 offen offset:0 lds
    buffer_load_dwordx4 v229, s[4:7], s28 offen offset:1024 lds
    buffer_load_dwordx4 v230, s[4:7], s28 offen offset:2048 lds
    buffer_load_dwordx4 v231, s[4:7], s28 offen offset:3072 lds
    v_and_b32 v1, 63, v0
    s_lshr_b32 s3, s2, 3
    s_lshl2_add_u32 s3, s3, s20
    s_and_b32 s3, s3, 31
    s_min_u32 s3, s3, (L_slow - L_pc) / 1024 - 4
    s_lshl_b32 s3, s3, 10
    s_add_u32 s3, s3, 4096
    s_add_u32 s34, s34, s3
    s_addc_u32 s35, s35, 0
    v_lshlrev_b32 v3, 4, v1
    v_add_co_u32 v252, vcc, s34, v3
    v_mov_b32 v253, s35
    s_nop 0
    v_addc_co_u32 v253, vcc, 0, v253, vcc
    s_add_u32 s12, s92, s30
    s_addc_u32 s13, s93, 0
    s_mov_b32 s14, 0x40000
    s_mov_b32 s15, 0x20000
    s_add_u32 s22, s21, 98304
    v_lshlrev_b32 v3, 1, v5
    v_xor_b32 v3, v6, v3
    v_lshl_add_u32 v232, v3, 4, v7
    v_xor_b32 v233, 0x80, v232
    s_add_u32 s16, s94, s31
    s_addc_u32 s17, s95, 0
    s_mov_b32 s18, 0x10000
    s_mov_b32 s19, 0x20000
    v_xor_b32 v3, v5, v6
    v_lshlrev_b32 v4, 8, v6
    v_lshl_add_u32 v216, v3, 4, v4
    v_xor_b32 v217, 64, v216
    v_xor_b32 v218, 128, v216
    v_xor_b32 v219, 192, v216
    v_add_u32 v244, s33, v216
    v_add_u32 v245, s33, v217
    v_add_u32 v246, s33, v218
    v_add_u32 v247, s33, v219
    s_mov_b32 s26, 0x3e0293ee
    s_mov_b32 s27, 0x3e0293ee
    s_mov_b32 s29, 0x4f800000
    s_mov_b32 s30, 0xffff0000
    v_lshrrev_b32 v3, 2, v1
    v_lshlrev_b32 v2, 8, v3
    v_and_b32 v3, 7, v3
    v_lshl_add_u32 v2, v3, 5, v2
    v_and_b32 v3, 3, v1
    v_lshl_add_u32 v2, v3, 3, v2
    v_add_u32 v220, 98304, v2
    v_xor_b32 v221, 32, v220
    v_xor_b32 v222, 64, v220
    v_xor_b32 v223, 96, v220
    v_xor_b32 v224, 128, v220
    v_xor_b32 v225, 160, v220
    v_xor_b32 v226, 192, v220
    v_xor_b32 v227, 224, v220
    s_mul_i32 s32, s20, 17408
    v_mul_u32_u24 v3, 272, v6
    v_lshl_add_u32 v3, v5, 3, v3
    v_add_u32 v234, s32, v3
    v_add_u32 v235, 4352, v234
    v_add_u32 v236, 8704, v234
    v_add_u32 v237, 13056, v234
    v_lshrrev_b32 v2, 3, v1
    v_and_b32 v4, 7, v1
    v_mul_u32_u24 v3, 272, v2
    v_lshl_add_u32 v3, v4, 4, v3
    v_add_u32 v238, s32, v3
    s_lshl_b32 s3, s20, 14
    v_lshlrev_b32 v3, 8, v2
    v_lshl_add_u32 v3, v4, 4, v3
    v_add_u32 v240, s3, v3
    s_movk_i32 s81, 4096
    s_movk_i32 s82, 8192
    s_movk_i32 s83, 12288
    v_and_b32 v3, 2, v1
    v_cmp_eq_u32 vcc, 0, v3
    v_mov_b32 v2, 0x3f803f80
    s_mov_b32 s25, 0
    v_cndmask_b32 v3, 0, v2, vcc
    v_accvgpr_write_b32 a208, v3
    v_accvgpr_write_b32 a209, v3
    v_accvgpr_write_b32 a210, v3
    v_accvgpr_write_b32 a211, v3
    v_and_b32 v3, 1, v1
    v_cmp_eq_u32 vcc, 0, v3
    v_mov_b32 v2, 0x44444444
    v_mov_b32 v3, 0xeeeeeeee
    v_cndmask_b32 v168, v3, v2, vcc
    v_accvgpr_write_b32 a192, 0
    v_accvgpr_write_b32 a193, 0
    v_accvgpr_write_b32 a194, 0
    v_accvgpr_write_b32 a195, 0
    v_accvgpr_write_b32 a196, 0
    v_accvgpr_write_b32 a197, 0
    v_accvgpr_write_b32 a198, 0
    v_accvgpr_write_b32 a199, 0
    v_accvgpr_write_b32 a200, 0
    v_accvgpr_write_b32 a201, 0
    v_accvgpr_write_b32 a202, 0
    v_accvgpr_write_b32 a203, 0
    v_accvgpr_write_b32 a204, 0
    v_accvgpr_write_b32 a205, 0
    v_accvgpr_write_b32 a206, 0
    v_accvgpr_write_b32 a207, 0
    s_bitcmp1_b32 s2, 3
    s_cbranch_scc1 L_role1
    s_mov_b32 s24, 0
    s_add_u32 m0, s22, 16384
    s_nop 0
    buffer_load_dwordx4 v232, s[12:15], s24 offen offset:0 lds
    buffer_load_dwordx4 v233, s[12:15], s24 offen offset:1024 lds
    buffer_load_dwordx4 v232, s[12:15], s24 offen offset:2048 lds
    buffer_load_dwordx4 v233, s[12:15], s24 offen offset:3072 lds
    s_add_u32 m0, s33, 4096
    s_add_u32 s28, s84, 4096
    buffer_load_dwordx4 v228, s[4:7], s28 offen offset:0 lds
    buffer_load_dwordx4 v229, s[4:7], s28 offen offset:1024 lds
    buffer_load_dwordx4 v230, s[4:7], s28 offen offset:2048 lds
    buffer_load_dwordx4 v231, s[4:7], s28 offen offset:3072 lds
    s_waitcnt vmcnt(8)
    ds_read_b128 v[104:107], v244 offset:0
    ds_read_b128 v[108:111], v245 offset:0
    ds_read_b128 v[112:115], v246 offset:0
    ds_read_b128 v[116:119], v247 offset:0
    s_add_u32 m0, s33, 8192
    s_add_u32 s28, s84, 8192
    buffer_load_dwordx4 v228, s[4:7], s28 offen offset:0 lds
    s_waitcnt lgkmcnt(3)
    v_lshlrev_b32 v120, 16, v104
    v_and_b32 v121, s30, v104
    v_lshlrev_b32 v122, 16, v105
    v_and_b32 v123, s30, v105
    v_lshlrev_b32 v124, 16, v106
    v_and_b32 v125, s30, v106
    v_lshlrev_b32 v126, 16, v107
    v_and_b32 v127, s30, v107
    v_pk_mul_f32 v[120:121], v[120:121], s[26:27]
    v_pk_mul_f32 v[122:123], v[122:123], s[26:27]
    v_pk_mul_f32 v[124:125], v[124:125], s[26:27]
    v_pk_mul_f32 v[126:127], v[126:127], s[26:27]
    v_cvt_pk_bf16_f32 v120, v120, v121
    v_cvt_pk_bf16_f32 v122, v122, v123
    buffer_load_dwordx4 v229, s[4:7], s28 offen offset:1024 lds
    v_cvt_pk_bf16_f32 v124, v124, v125
    v_cvt_pk_bf16_f32 v126, v126, v127
    v_accvgpr_write_b32 a0, v120
    v_accvgpr_write_b32 a1, v122
    v_accvgpr_write_b32 a2, v124
    v_accvgpr_write_b32 a3, v126
    s_waitcnt lgkmcnt(0)
    v_lshlrev_b32 v128, 16, v108
    v_and_b32 v129, s30, v108
    v_lshlrev_b32 v130, 16, v109
    v_and_b32 v131, s30, v109
    v_lshlrev_b32 v132, 16, v110
    v_and_b32 v133, s30, v110
    v_lshlrev_b32 v134, 16, v111
    v_and_b32 v135, s30, v111
    buffer_load_dwordx4 v230, s[4:7], s28 offen offset:2048 lds
    v_pk_mul_f32 v[128:129], v[128:129], s[26:27]
    v_pk_mul_f32 v[130:131], v[130:131], s[26:27]
    v_pk_mul_f32 v[132:133], v[132:133], s[26:27]
    v_pk_mul_f32 v[134:135], v[134:135], s[26:27]
    v_cvt_pk_bf16_f32 v128, v128, v129
    v_cvt_pk_bf16_f32 v130, v130, v131
    v_cvt_pk_bf16_f32 v132, v132, v133
    v_cvt_pk_bf16_f32 v134, v134, v135
    v_accvgpr_write_b32 a4, v128
    v_accvgpr_write_b32 a5, v130
    v_accvgpr_write_b32 a6, v132
    v_accvgpr_write_b32 a7, v134
    v_lshlrev_b32 v120, 16, v112
    v_and_b32 v121, s30, v112
    buffer_load_dwordx4 v231, s[4:7], s28 offen offset:3072 lds
    v_lshlrev_b32 v122, 16, v113
    v_and_b32 v123, s30, v113
    v_lshlrev_b32 v124, 16, v114
    v_and_b32 v125, s30, v114
    v_lshlrev_b32 v126, 16, v115
    v_and_b32 v127, s30, v115
    v_pk_mul_f32 v[120:121], v[120:121], s[26:27]
    v_pk_mul_f32 v[122:123], v[122:123], s[26:27]
    v_pk_mul_f32 v[124:125], v[124:125], s[26:27]
    v_pk_mul_f32 v[126:127], v[126:127], s[26:27]
    v_cvt_pk_bf16_f32 v120, v120, v121
    v_cvt_pk_bf16_f32 v122, v122, v123
    v_cvt_pk_bf16_f32 v124, v124, v125
    v_cvt_pk_bf16_f32 v126, v126, v127
    global_load_dwordx4 v[252:255], v[252:253], off
    v_accvgpr_write_b32 a8, v120
    v_accvgpr_write_b32 a9, v122
    v_accvgpr_write_b32 a10, v124
    v_accvgpr_write_b32 a11, v126
    v_lshlrev_b32 v128, 16, v116
    v_and_b32 v129, s30, v116
    v_lshlrev_b32 v130, 16, v117
    v_and_b32 v131, s30, v117
    v_lshlrev_b32 v132, 16, v118
    v_and_b32 v133, s30, v118
    v_lshlrev_b32 v134, 16, v119
    v_and_b32 v135, s30, v119
    v_pk_mul_f32 v[128:129], v[128:129], s[26:27]
    v_pk_mul_f32 v[130:131], v[130:131], s[26:27]
    v_pk_mul_f32 v[132:133], v[132:133], s[26:27]
    v_pk_mul_f32 v[134:135], v[134:135], s[26:27]
    v_cvt_pk_bf16_f32 v128, v128, v129
    v_cvt_pk_bf16_f32 v130, v130, v131
    v_cvt_pk_bf16_f32 v132, v132, v133
    v_cvt_pk_bf16_f32 v134, v134, v135
    v_accvgpr_write_b32 a12, v128
    v_accvgpr_write_b32 a13, v130
    v_accvgpr_write_b32 a14, v132
    v_accvgpr_write_b32 a15, v134
    s_barrier
    ds_read_b128 a[64:67], v216 offset:0
    ds_read_b128 a[80:83], v216 offset:4096
    ds_read_b128 a[96:99], v216 offset:8192
    ds_read_b128 a[112:115], v216 offset:12288
    ds_read_b128 a[68:71], v217 offset:0
    ds_read_b128 a[84:87], v217 offset:4096
    ds_read_b128 a[100:103], v217 offset:8192
    ds_read_b128 a[116:119], v217 offset:12288
    ds_read_b128 a[72:75], v218 offset:0
    ds_read_b128 a[88:91], v218 offset:4096
    ds_read_b128 a[104:107], v218 offset:8192
    ds_read_b128 a[120:123], v218 offset:12288
    s_waitcnt lgkmcnt(11)
    v_mfma_f32_16x16x32_bf16 v[136:139], a[64:67], a[0:3], 0
    s_waitcnt lgkmcnt(10)
    ds_read_b128 a[76:79], v219 offset:0
    ds_read_b128 a[92:95], v219 offset:4096
    ds_read_b128 a[108:111], v219 offset:8192
    ds_read_b128 a[124:127], v219 offset:12288
    v_mfma_f32_16x16x32_bf16 v[140:143], a[80:83], a[0:3], 0
    s_waitcnt lgkmcnt(13)
    v_mfma_f32_16x16x32_bf16 v[144:147], a[96:99], a[0:3], 0
    s_waitcnt lgkmcnt(12)
    v_mfma_f32_16x16x32_bf16 v[148:151], a[112:115], a[0:3], 0
    s_waitcnt lgkmcnt(11)
    v_mfma_f32_16x16x32_bf16 v[136:139], a[68:71], a[4:7], v[136:139]
    s_waitcnt lgkmcnt(10)
    v_mfma_f32_16x16x32_bf16 v[140:143], a[84:87], a[4:7], v[140:143]
    s_waitcnt lgkmcnt(9)
    v_mfma_f32_16x16x32_bf16 v[144:147], a[100:103], a[4:7], v[144:147]
    s_waitcnt lgkmcnt(8)
    v_mfma_f32_16x16x32_bf16 v[148:151], a[116:119], a[4:7], v[148:151]
    s_waitcnt lgkmcnt(7)
    v_mfma_f32_16x16x32_bf16 v[136:139], a[72:75], a[8:11], v[136:139]
    s_waitcnt lgkmcnt(6)
    v_mfma_f32_16x16x32_bf16 v[140:143], a[88:91], a[8:11], v[140:143]
    s_waitcnt lgkmcnt(5)
    v_mfma_f32_16x16x32_bf16 v[144:147], a[104:107], a[8:11], v[144:147]
    s_waitcnt lgkmcnt(4)
    v_mfma_f32_16x16x32_bf16 v[148:151], a[120:123], a[8:11], v[148:151]
    s_waitcnt lgkmcnt(3)
    v_mfma_f32_16x16x32_bf16 v[136:139], a[76:79], a[12:15], v[136:139]
    s_waitcnt lgkmcnt(2)
    v_mfma_f32_16x16x32_bf16 v[140:143], a[92:95], a[12:15], v[140:143]
    s_waitcnt lgkmcnt(1)
    v_mfma_f32_16x16x32_bf16 v[144:147], a[108:111], a[12:15], v[144:147]
    s_waitcnt lgkmcnt(0)
    v_mfma_f32_16x16x32_bf16 v[148:151], a[124:127], a[12:15], v[148:151]
    s_nop 1
    v_max3_f32 v248, v136, v137, v138
    s_nop 0
    v_max3_f32 v249, v140, v141, v142
    v_max3_f32 v248, v248, v139, v143
    v_max_f32 v248, v248, v249
    v_mov_b32 v249, v248
    s_nop 1
    v_permlane32_swap_b32 v248, v249
    v_max_f32 v248, v248, v249
    v_mov_b32 v249, v248
    s_nop 1
    v_permlane16_swap_b32 v248, v249
    v_max_f32 v248, v248, v249
    v_sub_f32 v200, 0, v248
    v_sub_f32 v201, 0, v248
    v_sub_f32 v202, 0, v248
    v_sub_f32 v203, 0, v248
    v_add_f32 v136, v136, v200
    v_add_f32 v137, v137, v200
    v_add_f32 v138, v138, v200
    v_add_f32 v139, v139, v200
    v_add_f32 v140, v140, v200
    v_add_f32 v141, v141, v200
    v_add_f32 v142, v142, v200
    v_add_f32 v143, v143, v200
    v_add_f32 v144, v144, v200
    v_add_f32 v145, v145, v200
    v_add_f32 v146, v146, v200
    v_add_f32 v147, v147, v200
    v_add_f32 v148, v148, v200
    v_add_f32 v149, v149, v200
    v_add_f32 v150, v150, v200
    v_add_f32 v151, v151, v200
    v_exp_f32 v136, v136
    v_exp_f32 v137, v137
    v_exp_f32 v138, v138
    v_cvt_pk_bf16_f32 v136, v136, v137
    v_exp_f32 v139, v139
    v_exp_f32 v140, v140
    v_cvt_pk_bf16_f32 v137, v138, v139
    v_exp_f32 v141, v141
    v_exp_f32 v142, v142
    s_waitcnt vmcnt(5)
    s_barrier
    ds_read_b128 v[104:107], v244 offset:4096
    ds_read_b128 v[108:111], v245 offset:4096
    ds_read_b128 v[112:115], v246 offset:4096
    ds_read_b128 v[116:119], v247 offset:4096
    s_add_u32 m0, s33, 12288
    s_add_u32 s28, s84, 12288
    buffer_load_dwordx4 v228, s[4:7], s28 offen offset:0 lds
    v_cvt_pk_bf16_f32 v138, v140, v141
    v_exp_f32 v143, v143
    v_exp_f32 v144, v144
    v_cvt_pk_bf16_f32 v139, v142, v143
    v_exp_f32 v145, v145
    v_exp_f32 v146, v146
    v_cvt_pk_bf16_f32 v140, v144, v145
    v_exp_f32 v147, v147
    v_exp_f32 v148, v148
    v_cvt_pk_bf16_f32 v141, v146, v147
    v_exp_f32 v149, v149
    v_exp_f32 v150, v150
    v_cvt_pk_bf16_f32 v142, v148, v149
    v_exp_f32 v151, v151
    buffer_load_dwordx4 v229, s[4:7], s28 offen offset:1024 lds
    s_nop 0
    v_cvt_pk_bf16_f32 v143, v150, v151
    s_waitcnt lgkmcnt(3)
    v_lshlrev_b32 v120, 16, v104
    v_and_b32 v121, s30, v104
    v_lshlrev_b32 v122, 16, v105
    v_and_b32 v123, s30, v105
    v_lshlrev_b32 v124, 16, v106
    v_and_b32 v125, s30, v106
    v_lshlrev_b32 v126, 16, v107
    v_and_b32 v127, s30, v107
    v_pk_mul_f32 v[120:121], v[120:121], s[26:27]
    v_pk_mul_f32 v[122:123], v[122:123], s[26:27]
    v_pk_mul_f32 v[124:125], v[124:125], s[26:27]
    v_pk_mul_f32 v[126:127], v[126:127], s[26:27]
    buffer_load_dwordx4 v230, s[4:7], s28 offen offset:2048 lds
    v_cvt_pk_bf16_f32 v120, v120, v121
    v_cvt_pk_bf16_f32 v122, v122, v123
    v_cvt_pk_bf16_f32 v124, v124, v125
    v_cvt_pk_bf16_f32 v126, v126, v127
    v_accvgpr_write_b32 a16, v120
    v_accvgpr_write_b32 a17, v122
    v_accvgpr_write_b32 a18, v124
    v_accvgpr_write_b32 a19, v126
    s_waitcnt lgkmcnt(0)
    v_lshlrev_b32 v128, 16, v108
    v_and_b32 v129, s30, v108
    v_lshlrev_b32 v130, 16, v109
    v_and_b32 v131, s30, v109
    v_lshlrev_b32 v132, 16, v110
    v_and_b32 v133, s30, v110
    buffer_load_dwordx4 v231, s[4:7], s28 offen offset:3072 lds
    v_lshlrev_b32 v134, 16, v111
    v_and_b32 v135, s30, v111
    v_pk_mul_f32 v[128:129], v[128:129], s[26:27]
    v_pk_mul_f32 v[130:131], v[130:131], s[26:27]
    v_pk_mul_f32 v[132:133], v[132:133], s[26:27]
    v_pk_mul_f32 v[134:135], v[134:135], s[26:27]
    v_mfma_f32_16x16x32_bf16 v[152:155], a[64:67], a[16:19], 0
    ds_read_b64_tr_b16 a[128:129], v220 offset:16384
    ds_read_b64_tr_b16 a[130:131], v220 offset:20480
    v_cvt_pk_bf16_f32 v128, v128, v129
    v_cvt_pk_bf16_f32 v130, v130, v131
    v_mfma_f32_16x16x32_bf16 v[156:159], a[80:83], a[16:19], 0
    ds_read_b64_tr_b16 a[160:161], v220 offset:24576
    ds_read_b64_tr_b16 a[162:163], v220 offset:28672
    v_cvt_pk_bf16_f32 v132, v132, v133
    v_cvt_pk_bf16_f32 v134, v134, v135
    v_mfma_f32_16x16x32_bf16 v[160:163], a[96:99], a[16:19], 0
    ds_read_b64_tr_b16 a[132:133], v221 offset:16384
    ds_read_b64_tr_b16 a[134:135], v221 offset:20480
    v_accvgpr_write_b32 a20, v128
    v_accvgpr_write_b32 a21, v130
    v_mfma_f32_16x16x32_bf16 v[164:167], a[112:115], a[16:19], 0
    ds_read_b64_tr_b16 a[164:165], v221 offset:24576
    ds_read_b64_tr_b16 a[166:167], v221 offset:28672
    v_accvgpr_write_b32 a22, v132
    v_accvgpr_write_b32 a23, v134
    v_lshlrev_b32 v120, 16, v112
    v_and_b32 v121, s30, v112
    v_lshlrev_b32 v122, 16, v113
    v_and_b32 v123, s30, v113
    v_lshlrev_b32 v124, 16, v114
    v_and_b32 v125, s30, v114
    v_lshlrev_b32 v126, 16, v115
    v_and_b32 v127, s30, v115
    v_pk_mul_f32 v[120:121], v[120:121], s[26:27]
    v_pk_mul_f32 v[122:123], v[122:123], s[26:27]
    v_pk_mul_f32 v[124:125], v[124:125], s[26:27]
    v_pk_mul_f32 v[126:127], v[126:127], s[26:27]
    v_mfma_f32_16x16x32_bf16 v[152:155], a[68:71], a[20:23], v[152:155]
    ds_read_b64_tr_b16 a[136:137], v222 offset:16384
    ds_read_b64_tr_b16 a[138:139], v222 offset:20480
    v_cvt_pk_bf16_f32 v120, v120, v121
    v_cvt_pk_bf16_f32 v122, v122, v123
    v_mfma_f32_16x16x32_bf16 v[156:159], a[84:87], a[20:23], v[156:159]
    ds_read_b64_tr_b16 a[168:169], v222 offset:24576
    ds_read_b64_tr_b16 a[170:171], v222 offset:28672
    v_cvt_pk_bf16_f32 v124, v124, v125
    v_cvt_pk_bf16_f32 v126, v126, v127
    v_mfma_f32_16x16x32_bf16 v[160:163], a[100:103], a[20:23], v[160:163]
    ds_read_b64_tr_b16 a[140:141], v223 offset:16384
    ds_read_b64_tr_b16 a[142:143], v223 offset:20480
    v_accvgpr_write_b32 a24, v120
    v_accvgpr_write_b32 a25, v122
    v_mfma_f32_16x16x32_bf16 v[164:167], a[116:119], a[20:23], v[164:167]
    ds_read_b64_tr_b16 a[172:173], v223 offset:24576
    ds_read_b64_tr_b16 a[174:175], v223 offset:28672
    v_accvgpr_write_b32 a26, v124
    v_accvgpr_write_b32 a27, v126
    v_lshlrev_b32 v128, 16, v116
    v_and_b32 v129, s30, v116
    v_lshlrev_b32 v130, 16, v117
    v_and_b32 v131, s30, v117
    v_lshlrev_b32 v132, 16, v118
    v_and_b32 v133, s30, v118
    v_lshlrev_b32 v134, 16, v119
    v_and_b32 v135, s30, v119
    v_pk_mul_f32 v[128:129], v[128:129], s[26:27]
    v_pk_mul_f32 v[130:131], v[130:131], s[26:27]
    v_pk_mul_f32 v[132:133], v[132:133], s[26:27]
    v_pk_mul_f32 v[134:135], v[134:135], s[26:27]
    v_mfma_f32_16x16x32_bf16 v[152:155], a[72:75], a[24:27], v[152:155]
    ds_read_b64_tr_b16 a[144:145], v224 offset:16384
    ds_read_b64_tr_b16 a[146:147], v224 offset:20480
    v_cvt_pk_bf16_f32 v128, v128, v129
    v_cvt_pk_bf16_f32 v130, v130, v131
    v_mfma_f32_16x16x32_bf16 v[156:159], a[88:91], a[24:27], v[156:159]
    ds_read_b64_tr_b16 a[176:177], v224 offset:24576
    ds_read_b64_tr_b16 a[178:179], v224 offset:28672
    v_cvt_pk_bf16_f32 v132, v132, v133
    v_cvt_pk_bf16_f32 v134, v134, v135
    v_mfma_f32_16x16x32_bf16 v[160:163], a[104:107], a[24:27], v[160:163]
    ds_read_b64_tr_b16 a[148:149], v225 offset:16384
    ds_read_b64_tr_b16 a[150:151], v225 offset:20480
    v_accvgpr_write_b32 a28, v128
    v_accvgpr_write_b32 a29, v130
    v_mfma_f32_16x16x32_bf16 v[164:167], a[120:123], a[24:27], v[164:167]
    ds_read_b64_tr_b16 a[180:181], v225 offset:24576
    ds_read_b64_tr_b16 a[182:183], v225 offset:28672
    v_accvgpr_write_b32 a30, v132
    v_accvgpr_write_b32 a31, v134
    s_nop 0
    s_nop 0
    v_mfma_f32_16x16x32_bf16 v[152:155], a[76:79], a[28:31], v[152:155]
    ds_read_b64_tr_b16 a[152:153], v226 offset:16384
    ds_read_b64_tr_b16 a[154:155], v226 offset:20480
    v_mfma_f32_16x16x32_bf16 v[156:159], a[92:95], a[28:31], v[156:159]
    ds_read_b64_tr_b16 a[184:185], v226 offset:24576
    ds_read_b64_tr_b16 a[186:187], v226 offset:28672
    v_mfma_f32_16x16x32_bf16 v[160:163], a[108:111], a[28:31], v[160:163]
    ds_read_b64_tr_b16 a[156:157], v227 offset:16384
    ds_read_b64_tr_b16 a[158:159], v227 offset:20480
    v_mfma_f32_16x16x32_bf16 v[164:167], a[124:127], a[28:31], v[164:167]
    ds_read_b64_tr_b16 a[188:189], v227 offset:24576
    ds_read_b64_tr_b16 a[190:191], v227 offset:28672
    v_smfmac_f32_16x16x64_bf16 a[192:195], a[208:211], v[136:143], v168
    s_waitcnt lgkmcnt(12)
    v_mfma_f32_16x16x32_bf16 v[8:11], a[128:131], v[136:139], 0
    v_mfma_f32_16x16x32_bf16 v[8:11], a[160:163], v[140:143], v[8:11]
    v_max3_f32 v250, v152, v153, v154
    v_max3_f32 v251, v156, v157, v158
    v_max3_f32 v250, v250, v155, v159
    v_max_f32 v250, v250, v251
    v_mfma_f32_16x16x32_bf16 v[12:15], a[132:135], v[136:139], 0
    v_mov_b32 v251, v250
    s_nop 1
    v_mfma_f32_16x16x32_bf16 v[12:15], a[164:167], v[140:143], v[12:15]
    v_permlane32_swap_b32 v250, v251
    v_max_f32 v250, v250, v251
    v_mov_b32 v251, v250
    v_mfma_f32_16x16x32_bf16 v[16:19], a[136:139], v[136:139], 0
    s_nop 1
    v_permlane16_swap_b32 v250, v251
    v_mfma_f32_16x16x32_bf16 v[16:19], a[168:171], v[140:143], v[16:19]
    v_max_f32 v250, v250, v251
    v_sub_f32 v204, 0, v250
    v_sub_f32 v205, 0, v250
    v_sub_f32 v206, 0, v250
    v_mfma_f32_16x16x32_bf16 v[20:23], a[140:143], v[136:139], 0
    v_sub_f32 v207, 0, v250
    v_add_f32 v152, v152, v204
    v_add_f32 v153, v153, v204
    v_add_f32 v154, v154, v204
    v_mfma_f32_16x16x32_bf16 v[20:23], a[172:175], v[140:143], v[20:23]
    v_add_f32 v155, v155, v204
    v_add_f32 v156, v156, v204
    v_add_f32 v157, v157, v204
    v_add_f32 v158, v158, v204
    v_mfma_f32_16x16x32_bf16 v[24:27], a[144:147], v[136:139], 0
    v_add_f32 v159, v159, v204
    v_add_f32 v160, v160, v204
    v_add_f32 v161, v161, v204
    v_add_f32 v162, v162, v204
    v_mfma_f32_16x16x32_bf16 v[24:27], a[176:179], v[140:143], v[24:27]
    s_waitcnt lgkmcnt(0)
    v_add_f32 v163, v163, v204
    v_add_f32 v164, v164, v204
    v_add_f32 v165, v165, v204
    v_add_f32 v166, v166, v204
    v_mfma_f32_16x16x32_bf16 v[28:31], a[148:151], v[136:139], 0
    v_add_f32 v167, v167, v204
    v_exp_f32 v152, v152
    v_mfma_f32_16x16x32_bf16 v[28:31], a[180:183], v[140:143], v[28:31]
    v_exp_f32 v153, v153
    v_exp_f32 v154, v154
    v_mfma_f32_16x16x32_bf16 v[32:35], a[152:155], v[136:139], 0
    v_cvt_pk_bf16_f32 v152, v152, v153
    v_exp_f32 v155, v155
    v_mfma_f32_16x16x32_bf16 v[32:35], a[184:187], v[140:143], v[32:35]
    v_exp_f32 v156, v156
    v_cvt_pk_bf16_f32 v153, v154, v155
    v_mfma_f32_16x16x32_bf16 v[36:39], a[156:159], v[136:139], 0
    v_exp_f32 v157, v157
    v_exp_f32 v158, v158
    v_mfma_f32_16x16x32_bf16 v[36:39], a[188:191], v[140:143], v[36:39]
    s_waitcnt vmcnt(5)
    ds_read_b128 v[104:107], v244 offset:8192
    ds_read_b128 v[108:111], v245 offset:8192
    ds_read_b128 v[112:115], v246 offset:8192
    ds_read_b128 v[116:119], v247 offset:8192
    s_mov_b32 s23, 16384
    s_add_u32 m0, s21, 16384
    s_nop 0
    buffer_load_dwordx4 v228, s[8:11], s23 offen offset:0 lds
    v_cvt_pk_bf16_f32 v154, v156, v157
    v_exp_f32 v159, v159
    v_exp_f32 v160, v160
    v_cvt_pk_bf16_f32 v155, v158, v159
    v_exp_f32 v161, v161
    v_exp_f32 v162, v162
    v_cvt_pk_bf16_f32 v156, v160, v161
    v_exp_f32 v163, v163
    v_exp_f32 v164, v164
    v_cvt_pk_bf16_f32 v157, v162, v163
    v_exp_f32 v165, v165
    v_exp_f32 v166, v166
    v_cvt_pk_bf16_f32 v158, v164, v165
    v_exp_f32 v167, v167
    buffer_load_dwordx4 v229, s[8:11], s23 offen offset:1024 lds
    s_nop 0
    v_cvt_pk_bf16_f32 v159, v166, v167
    s_waitcnt lgkmcnt(2)
    v_lshlrev_b32 v120, 16, v104
    v_and_b32 v121, s30, v104
    v_lshlrev_b32 v122, 16, v105
    v_and_b32 v123, s30, v105
    v_lshlrev_b32 v124, 16, v106
    v_and_b32 v125, s30, v106
    v_lshlrev_b32 v126, 16, v107
    v_and_b32 v127, s30, v107
    v_pk_mul_f32 v[120:121], v[120:121], s[26:27]
    v_pk_mul_f32 v[122:123], v[122:123], s[26:27]
    v_pk_mul_f32 v[124:125], v[124:125], s[26:27]
    v_pk_mul_f32 v[126:127], v[126:127], s[26:27]
    buffer_load_dwordx4 v230, s[8:11], s23 offen offset:2048 lds
    v_cvt_pk_bf16_f32 v120, v120, v121
    v_cvt_pk_bf16_f32 v122, v122, v123
    v_cvt_pk_bf16_f32 v124, v124, v125
    v_cvt_pk_bf16_f32 v126, v126, v127
    v_accvgpr_write_b32 a32, v120
    v_accvgpr_write_b32 a33, v122
    v_accvgpr_write_b32 a34, v124
    v_accvgpr_write_b32 a35, v126
    v_lshlrev_b32 v128, 16, v108
    v_and_b32 v129, s30, v108
    v_lshlrev_b32 v130, 16, v109
    v_and_b32 v131, s30, v109
    v_lshlrev_b32 v132, 16, v110
    v_and_b32 v133, s30, v110
    buffer_load_dwordx4 v231, s[8:11], s23 offen offset:3072 lds
    v_lshlrev_b32 v134, 16, v111
    v_and_b32 v135, s30, v111
    v_pk_mul_f32 v[128:129], v[128:129], s[26:27]
    v_pk_mul_f32 v[130:131], v[130:131], s[26:27]
    v_pk_mul_f32 v[132:133], v[132:133], s[26:27]
    v_pk_mul_f32 v[134:135], v[134:135], s[26:27]
    v_mfma_f32_16x16x32_bf16 v[136:139], a[64:67], a[32:35], 0
    v_cvt_pk_bf16_f32 v128, v128, v129
    v_cvt_pk_bf16_f32 v130, v130, v131
    v_mfma_f32_16x16x32_bf16 v[140:143], a[80:83], a[32:35], 0
    v_cvt_pk_bf16_f32 v132, v132, v133
    v_cvt_pk_bf16_f32 v134, v134, v135
    v_mfma_f32_16x16x32_bf16 v[144:147], a[96:99], a[32:35], 0
    v_accvgpr_write_b32 a36, v128
    v_accvgpr_write_b32 a37, v130
    v_mfma_f32_16x16x32_bf16 v[148:151], a[112:115], a[32:35], 0
    v_accvgpr_write_b32 a38, v132
    v_accvgpr_write_b32 a39, v134
    s_waitcnt lgkmcnt(0)
    v_lshlrev_b32 v120, 16, v112
    v_and_b32 v121, s30, v112
    v_lshlrev_b32 v122, 16, v113
    v_and_b32 v123, s30, v113
    v_lshlrev_b32 v124, 16, v114
    v_and_b32 v125, s30, v114
    v_lshlrev_b32 v126, 16, v115
    v_and_b32 v127, s30, v115
    v_pk_mul_f32 v[120:121], v[120:121], s[26:27]
    v_pk_mul_f32 v[122:123], v[122:123], s[26:27]
    v_pk_mul_f32 v[124:125], v[124:125], s[26:27]
    v_pk_mul_f32 v[126:127], v[126:127], s[26:27]
    v_mfma_f32_16x16x32_bf16 v[136:139], a[68:71], a[36:39], v[136:139]
    v_cvt_pk_bf16_f32 v120, v120, v121
    v_cvt_pk_bf16_f32 v122, v122, v123
    v_mfma_f32_16x16x32_bf16 v[140:143], a[84:87], a[36:39], v[140:143]
    v_cvt_pk_bf16_f32 v124, v124, v125
    v_cvt_pk_bf16_f32 v126, v126, v127
    v_mfma_f32_16x16x32_bf16 v[144:147], a[100:103], a[36:39], v[144:147]
    v_accvgpr_write_b32 a40, v120
    v_accvgpr_write_b32 a41, v122
    v_mfma_f32_16x16x32_bf16 v[148:151], a[116:119], a[36:39], v[148:151]
    v_accvgpr_write_b32 a42, v124
    v_accvgpr_write_b32 a43, v126
    v_lshlrev_b32 v128, 16, v116
    v_and_b32 v129, s30, v116
    v_lshlrev_b32 v130, 16, v117
    v_and_b32 v131, s30, v117
    v_lshlrev_b32 v132, 16, v118
    v_and_b32 v133, s30, v118
    v_lshlrev_b32 v134, 16, v119
    v_and_b32 v135, s30, v119
    v_pk_mul_f32 v[128:129], v[128:129], s[26:27]
    v_pk_mul_f32 v[130:131], v[130:131], s[26:27]
    v_pk_mul_f32 v[132:133], v[132:133], s[26:27]
    v_pk_mul_f32 v[134:135], v[134:135], s[26:27]
    v_mfma_f32_16x16x32_bf16 v[136:139], a[72:75], a[40:43], v[136:139]
    v_cvt_pk_bf16_f32 v128, v128, v129
    v_cvt_pk_bf16_f32 v130, v130, v131
    v_mfma_f32_16x16x32_bf16 v[140:143], a[88:91], a[40:43], v[140:143]
    v_cvt_pk_bf16_f32 v132, v132, v133
    v_cvt_pk_bf16_f32 v134, v134, v135
    v_mfma_f32_16x16x32_bf16 v[144:147], a[104:107], a[40:43], v[144:147]
    v_accvgpr_write_b32 a44, v128
    v_accvgpr_write_b32 a45, v130
    v_mfma_f32_16x16x32_bf16 v[148:151], a[120:123], a[40:43], v[148:151]
    v_accvgpr_write_b32 a46, v132
    v_accvgpr_write_b32 a47, v134
    s_nop 0
    s_nop 0
    v_mfma_f32_16x16x32_bf16 v[136:139], a[76:79], a[44:47], v[136:139]
    v_mfma_f32_16x16x32_bf16 v[140:143], a[92:95], a[44:47], v[140:143]
    v_mfma_f32_16x16x32_bf16 v[144:147], a[108:111], a[44:47], v[144:147]
    v_mfma_f32_16x16x32_bf16 v[148:151], a[124:127], a[44:47], v[148:151]
    v_smfmac_f32_16x16x64_bf16 a[196:199], a[208:211], v[152:159], v168
    v_mfma_f32_16x16x32_bf16 v[40:43], a[128:131], v[152:155], 0
    v_mfma_f32_16x16x32_bf16 v[40:43], a[160:163], v[156:159], v[40:43]
    s_nop 1
    v_max3_f32 v248, v136, v137, v138
    v_max3_f32 v249, v140, v141, v142
    v_max3_f32 v248, v248, v139, v143
    v_max_f32 v248, v248, v249
    v_mfma_f32_16x16x32_bf16 v[44:47], a[132:135], v[152:155], 0
    v_mov_b32 v249, v248
    s_nop 1
    v_mfma_f32_16x16x32_bf16 v[44:47], a[164:167], v[156:159], v[44:47]
    v_permlane32_swap_b32 v248, v249
    v_max_f32 v248, v248, v249
    v_mov_b32 v249, v248
    v_mfma_f32_16x16x32_bf16 v[48:51], a[136:139], v[152:155], 0
    s_nop 1
    v_permlane16_swap_b32 v248, v249
    v_mfma_f32_16x16x32_bf16 v[48:51], a[168:171], v[156:159], v[48:51]
    v_max_f32 v248, v248, v249
    v_sub_f32 v208, 0, v248
    v_sub_f32 v209, 0, v248
    v_sub_f32 v210, 0, v248
    v_mfma_f32_16x16x32_bf16 v[52:55], a[140:143], v[152:155], 0
    v_sub_f32 v211, 0, v248
    v_add_f32 v136, v136, v208
    v_add_f32 v137, v137, v208
    v_add_f32 v138, v138, v208
    v_mfma_f32_16x16x32_bf16 v[52:55], a[172:175], v[156:159], v[52:55]
    v_add_f32 v139, v139, v208
    v_add_f32 v140, v140, v208
    v_add_f32 v141, v141, v208
    v_add_f32 v142, v142, v208
    v_mfma_f32_16x16x32_bf16 v[56:59], a[144:147], v[152:155], 0
    v_add_f32 v143, v143, v208
    v_add_f32 v144, v144, v208
    v_add_f32 v145, v145, v208
    v_add_f32 v146, v146, v208
    v_mfma_f32_16x16x32_bf16 v[56:59], a[176:179], v[156:159], v[56:59]
    v_add_f32 v147, v147, v208
    v_add_f32 v148, v148, v208
    v_add_f32 v149, v149, v208
    v_add_f32 v150, v150, v208
    v_mfma_f32_16x16x32_bf16 v[60:63], a[148:151], v[152:155], 0
    v_add_f32 v151, v151, v208
    v_exp_f32 v136, v136
    v_mfma_f32_16x16x32_bf16 v[60:63], a[180:183], v[156:159], v[60:63]
    v_exp_f32 v137, v137
    v_exp_f32 v138, v138
    v_mfma_f32_16x16x32_bf16 v[64:67], a[152:155], v[152:155], 0
    v_cvt_pk_bf16_f32 v136, v136, v137
    v_exp_f32 v139, v139
    v_mfma_f32_16x16x32_bf16 v[64:67], a[184:187], v[156:159], v[64:67]
    v_exp_f32 v140, v140
    v_cvt_pk_bf16_f32 v137, v138, v139
    v_mfma_f32_16x16x32_bf16 v[68:71], a[156:159], v[152:155], 0
    v_exp_f32 v141, v141
    v_exp_f32 v142, v142
    v_mfma_f32_16x16x32_bf16 v[68:71], a[188:191], v[156:159], v[68:71]
    s_waitcnt vmcnt(4)
    ds_read_b128 v[104:107], v244 offset:12288
    ds_read_b128 v[108:111], v245 offset:12288
    ds_read_b128 v[112:115], v246 offset:12288
    ds_read_b128 v[116:119], v247 offset:12288
    s_mov_b32 s24, 16384
    s_add_u32 m0, s22, 32768
    s_nop 0
    buffer_load_dwordx4 v232, s[12:15], s24 offen offset:0 lds
    v_cvt_pk_bf16_f32 v138, v140, v141
    v_exp_f32 v143, v143
    v_exp_f32 v144, v144
    v_cvt_pk_bf16_f32 v139, v142, v143
    v_exp_f32 v145, v145
    v_exp_f32 v146, v146
    v_cvt_pk_bf16_f32 v140, v144, v145
    v_exp_f32 v147, v147
    v_exp_f32 v148, v148
    v_cvt_pk_bf16_f32 v141, v146, v147
    v_exp_f32 v149, v149
    v_exp_f32 v150, v150
    v_cvt_pk_bf16_f32 v142, v148, v149
    v_exp_f32 v151, v151
    buffer_load_dwordx4 v233, s[12:15], s24 offen offset:1024 lds
    s_nop 0
    v_cvt_pk_bf16_f32 v143, v150, v151
    s_waitcnt lgkmcnt(2)
    v_lshlrev_b32 v120, 16, v104
    v_and_b32 v121, s30, v104
    v_lshlrev_b32 v122, 16, v105
    v_and_b32 v123, s30, v105
    v_lshlrev_b32 v124, 16, v106
    v_and_b32 v125, s30, v106
    v_lshlrev_b32 v126, 16, v107
    v_and_b32 v127, s30, v107
    v_pk_mul_f32 v[120:121], v[120:121], s[26:27]
    v_pk_mul_f32 v[122:123], v[122:123], s[26:27]
    v_pk_mul_f32 v[124:125], v[124:125], s[26:27]
    v_pk_mul_f32 v[126:127], v[126:127], s[26:27]
    buffer_load_dwordx4 v232, s[12:15], s24 offen offset:2048 lds
    v_cvt_pk_bf16_f32 v120, v120, v121
    v_cvt_pk_bf16_f32 v122, v122, v123
    v_cvt_pk_bf16_f32 v124, v124, v125
    v_cvt_pk_bf16_f32 v126, v126, v127
    v_accvgpr_write_b32 a48, v120
    v_accvgpr_write_b32 a49, v122
    v_accvgpr_write_b32 a50, v124
    v_accvgpr_write_b32 a51, v126
    v_lshlrev_b32 v128, 16, v108
    v_and_b32 v129, s30, v108
    v_lshlrev_b32 v130, 16, v109
    v_and_b32 v131, s30, v109
    v_lshlrev_b32 v132, 16, v110
    v_and_b32 v133, s30, v110
    buffer_load_dwordx4 v233, s[12:15], s24 offen offset:3072 lds
    v_lshlrev_b32 v134, 16, v111
    v_and_b32 v135, s30, v111
    v_pk_mul_f32 v[128:129], v[128:129], s[26:27]
    v_pk_mul_f32 v[130:131], v[130:131], s[26:27]
    v_pk_mul_f32 v[132:133], v[132:133], s[26:27]
    v_pk_mul_f32 v[134:135], v[134:135], s[26:27]
    v_mfma_f32_16x16x32_bf16 v[152:155], a[64:67], a[48:51], 0
    v_cvt_pk_bf16_f32 v128, v128, v129
    v_cvt_pk_bf16_f32 v130, v130, v131
    v_mfma_f32_16x16x32_bf16 v[156:159], a[80:83], a[48:51], 0
    v_cvt_pk_bf16_f32 v132, v132, v133
    v_cvt_pk_bf16_f32 v134, v134, v135
    v_mfma_f32_16x16x32_bf16 v[160:163], a[96:99], a[48:51], 0
    v_accvgpr_write_b32 a52, v128
    v_accvgpr_write_b32 a53, v130
    v_mfma_f32_16x16x32_bf16 v[164:167], a[112:115], a[48:51], 0
    v_accvgpr_write_b32 a54, v132
    v_accvgpr_write_b32 a55, v134
    s_waitcnt lgkmcnt(0)
    v_lshlrev_b32 v120, 16, v112
    v_and_b32 v121, s30, v112
    v_lshlrev_b32 v122, 16, v113
    v_and_b32 v123, s30, v113
    v_lshlrev_b32 v124, 16, v114
    v_and_b32 v125, s30, v114
    v_lshlrev_b32 v126, 16, v115
    v_and_b32 v127, s30, v115
    v_pk_mul_f32 v[120:121], v[120:121], s[26:27]
    v_pk_mul_f32 v[122:123], v[122:123], s[26:27]
    v_pk_mul_f32 v[124:125], v[124:125], s[26:27]
    v_pk_mul_f32 v[126:127], v[126:127], s[26:27]
    v_mfma_f32_16x16x32_bf16 v[152:155], a[68:71], a[52:55], v[152:155]
    v_cvt_pk_bf16_f32 v120, v120, v121
    v_cvt_pk_bf16_f32 v122, v122, v123
    v_mfma_f32_16x16x32_bf16 v[156:159], a[84:87], a[52:55], v[156:159]
    v_cvt_pk_bf16_f32 v124, v124, v125
    v_cvt_pk_bf16_f32 v126, v126, v127
    v_mfma_f32_16x16x32_bf16 v[160:163], a[100:103], a[52:55], v[160:163]
    v_accvgpr_write_b32 a56, v120
    v_accvgpr_write_b32 a57, v122
    v_mfma_f32_16x16x32_bf16 v[164:167], a[116:119], a[52:55], v[164:167]
    v_accvgpr_write_b32 a58, v124
    v_accvgpr_write_b32 a59, v126
    v_lshlrev_b32 v128, 16, v116
    v_and_b32 v129, s30, v116
    v_lshlrev_b32 v130, 16, v117
    v_and_b32 v131, s30, v117
    v_lshlrev_b32 v132, 16, v118
    v_and_b32 v133, s30, v118
    v_lshlrev_b32 v134, 16, v119
    v_and_b32 v135, s30, v119
    v_pk_mul_f32 v[128:129], v[128:129], s[26:27]
    v_pk_mul_f32 v[130:131], v[130:131], s[26:27]
    v_pk_mul_f32 v[132:133], v[132:133], s[26:27]
    v_pk_mul_f32 v[134:135], v[134:135], s[26:27]
    v_mfma_f32_16x16x32_bf16 v[152:155], a[72:75], a[56:59], v[152:155]
    v_cvt_pk_bf16_f32 v128, v128, v129
    v_cvt_pk_bf16_f32 v130, v130, v131
    v_mfma_f32_16x16x32_bf16 v[156:159], a[88:91], a[56:59], v[156:159]
    v_cvt_pk_bf16_f32 v132, v132, v133
    v_cvt_pk_bf16_f32 v134, v134, v135
    v_mfma_f32_16x16x32_bf16 v[160:163], a[104:107], a[56:59], v[160:163]
    v_accvgpr_write_b32 a60, v128
    v_accvgpr_write_b32 a61, v130
    v_mfma_f32_16x16x32_bf16 v[164:167], a[120:123], a[56:59], v[164:167]
    v_accvgpr_write_b32 a62, v132
    v_accvgpr_write_b32 a63, v134
    s_nop 0
    s_nop 0
    v_mfma_f32_16x16x32_bf16 v[152:155], a[76:79], a[60:63], v[152:155]
    v_mfma_f32_16x16x32_bf16 v[156:159], a[92:95], a[60:63], v[156:159]
    v_mfma_f32_16x16x32_bf16 v[160:163], a[108:111], a[60:63], v[160:163]
    v_mfma_f32_16x16x32_bf16 v[164:167], a[124:127], a[60:63], v[164:167]
    s_waitcnt vmcnt(4)
    s_barrier
    v_smfmac_f32_16x16x64_bf16 a[200:203], a[208:211], v[136:143], v168
    ds_read_b128 a[64:67], v216 offset:16384
    ds_read_b128 a[68:71], v217 offset:16384
    v_mfma_f32_16x16x32_bf16 v[72:75], a[128:131], v[136:139], 0
    ds_read_b128 a[72:75], v218 offset:16384
    ds_read_b128 a[76:79], v219 offset:16384
    v_max3_f32 v250, v152, v153, v154
    v_max3_f32 v251, v156, v157, v158
    v_mfma_f32_16x16x32_bf16 v[72:75], a[160:163], v[140:143], v[72:75]
    ds_read_b128 a[92:95], v219 offset:20480
    ds_read_b128 a[88:91], v218 offset:20480
    v_max3_f32 v250, v250, v155, v159
    v_max_f32 v250, v250, v251
    v_mfma_f32_16x16x32_bf16 v[76:79], a[132:135], v[136:139], 0
    s_mov_b32 s23, 32768
    s_add_u32 m0, s21, 32768
    s_nop 0
    buffer_load_dwordx4 v228, s[8:11], s23 offen offset:0 lds
    ds_read_b128 a[84:87], v217 offset:20480
    ds_read_b128 a[80:83], v216 offset:20480
    v_mov_b32 v251, v250
    v_mfma_f32_16x16x32_bf16 v[76:79], a[164:167], v[140:143], v[76:79]
    ds_read_b128 a[96:99], v216 offset:24576
    ds_read_b128 a[100:103], v217 offset:24576
    s_nop 1
    v_mfma_f32_16x16x32_bf16 v[80:83], a[136:139], v[136:139], 0
    ds_read_b128 a[104:107], v218 offset:24576
    ds_read_b128 a[108:111], v219 offset:24576
    v_permlane32_swap_b32 v250, v251
    v_mfma_f32_16x16x32_bf16 v[80:83], a[168:171], v[140:143], v[80:83]
    ds_read_b128 a[124:127], v219 offset:28672
    buffer_load_dwordx4 v229, s[8:11], s23 offen offset:1024 lds
    ds_read_b128 a[120:123], v218 offset:28672
    v_max_f32 v250, v250, v251
    v_mov_b32 v251, v250
    v_mfma_f32_16x16x32_bf16 v[84:87], a[140:143], v[136:139], 0
    ds_read_b128 a[116:119], v217 offset:28672
    ds_read_b128 a[112:115], v216 offset:28672
    s_nop 1
    v_mfma_f32_16x16x32_bf16 v[84:87], a[172:175], v[140:143], v[84:87]
    v_permlane16_swap_b32 v250, v251
    v_max_f32 v250, v250, v251
    v_sub_f32 v212, 0, v250
    v_mfma_f32_16x16x32_bf16 v[88:91], a[144:147], v[136:139], 0
    v_sub_f32 v213, 0, v250
    buffer_load_dwordx4 v230, s[8:11], s23 offen offset:2048 lds
    v_sub_f32 v214, 0, v250
    v_sub_f32 v215, 0, v250
    v_add_f32 v152, v152, v212
    v_mfma_f32_16x16x32_bf16 v[88:91], a[176:179], v[140:143], v[88:91]
    v_add_f32 v153, v153, v212
    v_add_f32 v154, v154, v212
    v_add_f32 v155, v155, v212
    v_add_f32 v156, v156, v212
    v_mfma_f32_16x16x32_bf16 v[92:95], a[148:151], v[136:139], 0
    v_add_f32 v157, v157, v212
    v_add_f32 v158, v158, v212
    v_add_f32 v159, v159, v212
    v_add_f32 v160, v160, v212
    v_mfma_f32_16x16x32_bf16 v[92:95], a[180:183], v[140:143], v[92:95]
    buffer_load_dwordx4 v231, s[8:11], s23 offen offset:3072 lds
    v_add_f32 v161, v161, v212
    v_add_f32 v162, v162, v212
    v_add_f32 v163, v163, v212
    v_add_f32 v164, v164, v212
    v_mfma_f32_16x16x32_bf16 v[96:99], a[152:155], v[136:139], 0
    v_add_f32 v165, v165, v212
    v_add_f32 v166, v166, v212
    v_add_f32 v167, v167, v212
    v_mfma_f32_16x16x32_bf16 v[96:99], a[184:187], v[140:143], v[96:99]
    v_exp_f32 v152, v152
    v_exp_f32 v153, v153
    v_mfma_f32_16x16x32_bf16 v[100:103], a[156:159], v[136:139], 0
    v_exp_f32 v154, v154
    s_mov_b32 s24, 32768
    s_add_u32 m0, s22, 49152
    s_nop 0
    buffer_load_dwordx4 v232, s[12:15], s24 offen offset:0 lds
    v_cvt_pk_bf16_f32 v152, v152, v153
    v_mfma_f32_16x16x32_bf16 v[100:103], a[188:191], v[140:143], v[100:103]
    s_waitcnt lgkmcnt(0)
    v_exp_f32 v155, v155
    v_exp_f32 v156, v156
    v_mfma_f32_16x16x32_bf16 v[136:139], a[64:67], a[0:3], v[200:203]
    v_cvt_pk_bf16_f32 v153, v154, v155
    v_exp_f32 v157, v157
    v_mfma_f32_16x16x32_bf16 v[136:139], a[68:71], a[4:7], v[136:139]
    v_exp_f32 v158, v158
    v_cvt_pk_bf16_f32 v154, v156, v157
    v_mfma_f32_16x16x32_bf16 v[136:139], a[72:75], a[8:11], v[136:139]
    v_exp_f32 v159, v159
    v_exp_f32 v160, v160
    v_mfma_f32_16x16x32_bf16 v[136:139], a[76:79], a[12:15], v[136:139]
    buffer_load_dwordx4 v233, s[12:15], s24 offen offset:1024 lds
    v_cvt_pk_bf16_f32 v155, v158, v159
    v_exp_f32 v161, v161
    v_mfma_f32_16x16x32_bf16 v[140:143], a[92:95], a[12:15], v[200:203]
    v_exp_f32 v162, v162
    v_cvt_pk_bf16_f32 v156, v160, v161
    v_mfma_f32_16x16x32_bf16 v[140:143], a[88:91], a[8:11], v[140:143]
    v_exp_f32 v163, v163
    v_exp_f32 v164, v164
    v_mfma_f32_16x16x32_bf16 v[140:143], a[84:87], a[4:7], v[140:143]
    v_cvt_pk_bf16_f32 v157, v162, v163
    v_exp_f32 v165, v165
    v_mfma_f32_16x16x32_bf16 v[140:143], a[80:83], a[0:3], v[140:143]
    v_exp_f32 v166, v166
    buffer_load_dwordx4 v232, s[12:15], s24 offen offset:2048 lds
    v_cvt_pk_bf16_f32 v158, v164, v165
    v_mfma_f32_16x16x32_bf16 v[144:147], a[96:99], a[0:3], v[200:203]
    v_exp_f32 v167, v167
    s_nop 0
    v_cvt_pk_bf16_f32 v159, v166, v167
    v_mfma_f32_16x16x32_bf16 v[144:147], a[100:103], a[4:7], v[144:147]
    v_exp_f32 v136, v136
    v_exp_f32 v137, v137
    v_mfma_f32_16x16x32_bf16 v[144:147], a[104:107], a[8:11], v[144:147]
    v_exp_f32 v138, v138
    v_cvt_pk_bf16_f32 v136, v136, v137
    v_mfma_f32_16x16x32_bf16 v[144:147], a[108:111], a[12:15], v[144:147]
    v_exp_f32 v139, v139
    buffer_load_dwordx4 v233, s[12:15], s24 offen offset:3072 lds
    v_exp_f32 v140, v140
    v_mfma_f32_16x16x32_bf16 v[148:151], a[124:127], a[12:15], v[200:203]
    v_cvt_pk_bf16_f32 v137, v138, v139
    v_exp_f32 v141, v141
    v_mfma_f32_16x16x32_bf16 v[148:151], a[120:123], a[8:11], v[148:151]
    v_exp_f32 v142, v142
    v_cvt_pk_bf16_f32 v138, v140, v141
    v_mfma_f32_16x16x32_bf16 v[148:151], a[116:119], a[4:7], v[148:151]
    v_exp_f32 v143, v143
    v_exp_f32 v144, v144
    v_mfma_f32_16x16x32_bf16 v[148:151], a[112:115], a[0:3], v[148:151]
    v_cvt_pk_bf16_f32 v139, v142, v143
    v_exp_f32 v145, v145
    v_smfmac_f32_16x16x64_bf16 a[204:207], a[208:211], v[152:159], v168
    s_waitcnt vmcnt(8)
    s_barrier
    v_exp_f32 v146, v146
    v_cvt_pk_bf16_f32 v140, v144, v145
    v_mfma_f32_16x16x32_bf16 v[104:107], a[128:131], v[152:155], 0
    s_mov_b32 s23, 49152
    s_add_u32 m0, s21, 49152
    s_nop 0
    buffer_load_dwordx4 v228, s[8:11], s23 offen offset:0 lds
    v_exp_f32 v147, v147
    v_mfma_f32_16x16x32_bf16 v[104:107], a[160:163], v[156:159], v[104:107]
    ds_read_b64_tr_b16 a[128:129], v220 offset:32768
    ds_read_b64_tr_b16 a[130:131], v220 offset:36864
    v_exp_f32 v148, v148
    v_cvt_pk_bf16_f32 v141, v146, v147
    v_mfma_f32_16x16x32_bf16 v[108:111], a[132:135], v[152:155], 0
    v_mfma_f32_16x16x32_bf16 v[108:111], a[164:167], v[156:159], v[108:111]
    ds_read_b64_tr_b16 a[160:161], v220 offset:40960
    ds_read_b64_tr_b16 a[162:163], v220 offset:45056
    v_mfma_f32_16x16x32_bf16 v[112:115], a[136:139], v[152:155], 0
    v_mfma_f32_16x16x32_bf16 v[112:115], a[168:171], v[156:159], v[112:115]
    ds_read_b64_tr_b16 a[132:133], v221 offset:32768
    buffer_load_dwordx4 v229, s[8:11], s23 offen offset:1024 lds
    ds_read_b64_tr_b16 a[134:135], v221 offset:36864
    v_mfma_f32_16x16x32_bf16 v[116:119], a[140:143], v[152:155], 0
    v_mfma_f32_16x16x32_bf16 v[116:119], a[172:175], v[156:159], v[116:119]
    ds_read_b64_tr_b16 a[164:165], v221 offset:40960
    ds_read_b64_tr_b16 a[166:167], v221 offset:45056
    v_mfma_f32_16x16x32_bf16 v[120:123], a[144:147], v[152:155], 0
    v_mfma_f32_16x16x32_bf16 v[120:123], a[176:179], v[156:159], v[120:123]
    ds_read_b64_tr_b16 a[136:137], v222 offset:32768
    ds_read_b64_tr_b16 a[138:139], v222 offset:36864
    v_mfma_f32_16x16x32_bf16 v[124:127], a[148:151], v[152:155], 0
    v_mfma_f32_16x16x32_bf16 v[124:127], a[180:183], v[156:159], v[124:127]
    ds_read_b64_tr_b16 a[168:169], v222 offset:40960
    ds_read_b64_tr_b16 a[170:171], v222 offset:45056
    v_mfma_f32_16x16x32_bf16 v[128:131], a[152:155], v[152:155], 0
    buffer_load_dwordx4 v230, s[8:11], s23 offen offset:2048 lds
    v_mfma_f32_16x16x32_bf16 v[128:131], a[184:187], v[156:159], v[128:131]
    ds_read_b64_tr_b16 a[140:141], v223 offset:32768
    ds_read_b64_tr_b16 a[142:143], v223 offset:36864
    v_mfma_f32_16x16x32_bf16 v[132:135], a[156:159], v[152:155], 0
    v_mfma_f32_16x16x32_bf16 v[132:135], a[188:191], v[156:159], v[132:135]
    ds_read_b64_tr_b16 a[172:173], v223 offset:40960
    ds_read_b64_tr_b16 a[174:175], v223 offset:45056
    buffer_load_dwordx4 v231, s[8:11], s23 offen offset:3072 lds
    s_mov_b32 s23, 65536
    s_mov_b32 s24, 49152
    v_mfma_f32_16x16x32_bf16 v[152:155], a[64:67], a[16:19], v[204:207]
    ds_read_b64_tr_b16 a[144:145], v224 offset:32768
    ds_read_b64_tr_b16 a[146:147], v224 offset:36864
    v_mfma_f32_16x16x32_bf16 v[152:155], a[68:71], a[20:23], v[152:155]
    v_exp_f32 v149, v149
    v_mfma_f32_16x16x32_bf16 v[152:155], a[72:75], a[24:27], v[152:155]
    ds_read_b64_tr_b16 a[176:177], v224 offset:40960
    v_cvt_pk_bf16_f32 v142, v148, v149
    v_mfma_f32_16x16x32_bf16 v[152:155], a[76:79], a[28:31], v[152:155]
    v_exp_f32 v150, v150
    v_mfma_f32_16x16x32_bf16 v[156:159], a[92:95], a[28:31], v[204:207]
    ds_read_b64_tr_b16 a[178:179], v224 offset:45056
    ds_read_b64_tr_b16 a[148:149], v225 offset:32768
    s_nop 0
    v_mfma_f32_16x16x32_bf16 v[156:159], a[88:91], a[24:27], v[156:159]
    v_exp_f32 v151, v151
    v_mfma_f32_16x16x32_bf16 v[156:159], a[84:87], a[20:23], v[156:159]
    ds_read_b64_tr_b16 a[150:151], v225 offset:36864
    v_cvt_pk_bf16_f32 v143, v150, v151
    v_mfma_f32_16x16x32_bf16 v[156:159], a[80:83], a[16:19], v[156:159]
    v_exp_f32 v152, v152
    v_mfma_f32_16x16x32_bf16 v[160:163], a[96:99], a[16:19], v[204:207]
    ds_read_b64_tr_b16 a[180:181], v225 offset:40960
    ds_read_b64_tr_b16 a[182:183], v225 offset:45056
    v_mfma_f32_16x16x32_bf16 v[160:163], a[100:103], a[20:23], v[160:163]
    v_exp_f32 v153, v153
    v_mfma_f32_16x16x32_bf16 v[160:163], a[104:107], a[24:27], v[160:163]
    ds_read_b64_tr_b16 a[152:153], v226 offset:32768
    v_cvt_pk_bf16_f32 v152, v152, v153
    v_mfma_f32_16x16x32_bf16 v[160:163], a[108:111], a[28:31], v[160:163]
    v_exp_f32 v154, v154
    v_mfma_f32_16x16x32_bf16 v[164:167], a[124:127], a[28:31], v[204:207]
    ds_read_b64_tr_b16 a[154:155], v226 offset:36864
    ds_read_b64_tr_b16 a[184:185], v226 offset:40960
    v_mfma_f32_16x16x32_bf16 v[164:167], a[120:123], a[24:27], v[164:167]
    v_exp_f32 v155, v155
    v_mfma_f32_16x16x32_bf16 v[164:167], a[116:119], a[20:23], v[164:167]
    ds_read_b64_tr_b16 a[186:187], v226 offset:45056
    v_cvt_pk_bf16_f32 v153, v154, v155
    v_mfma_f32_16x16x32_bf16 v[164:167], a[112:115], a[16:19], v[164:167]
    v_exp_f32 v156, v156
    v_smfmac_f32_16x16x64_bf16 a[192:195], a[208:211], v[136:143], v168
    s_waitcnt lgkmcnt(6)
    ds_read_b64_tr_b16 a[156:157], v227 offset:32768
    ds_read_b64_tr_b16 a[158:159], v227 offset:36864
    v_mfma_f32_16x16x32_bf16 v[8:11], a[128:131], v[136:139], v[8:11]
    v_exp_f32 v157, v157
    v_mfma_f32_16x16x32_bf16 v[8:11], a[160:163], v[140:143], v[8:11]
    ds_read_b64_tr_b16 a[188:189], v227 offset:40960
    v_cvt_pk_bf16_f32 v154, v156, v157
    v_mfma_f32_16x16x32_bf16 v[12:15], a[132:135], v[136:139], v[12:15]
    v_exp_f32 v158, v158
    v_mfma_f32_16x16x32_bf16 v[12:15], a[164:167], v[140:143], v[12:15]
    ds_read_b64_tr_b16 a[190:191], v227 offset:45056
    v_mfma_f32_16x16x32_bf16 v[16:19], a[136:139], v[136:139], v[16:19]
    v_exp_f32 v159, v159
    v_mfma_f32_16x16x32_bf16 v[16:19], a[168:171], v[140:143], v[16:19]
    v_cvt_pk_bf16_f32 v155, v158, v159
    v_mfma_f32_16x16x32_bf16 v[20:23], a[140:143], v[136:139], v[20:23]
    v_exp_f32 v160, v160
    v_mfma_f32_16x16x32_bf16 v[20:23], a[172:175], v[140:143], v[20:23]
    v_mfma_f32_16x16x32_bf16 v[24:27], a[144:147], v[136:139], v[24:27]
    v_exp_f32 v161, v161
    v_mfma_f32_16x16x32_bf16 v[24:27], a[176:179], v[140:143], v[24:27]
    v_cvt_pk_bf16_f32 v156, v160, v161
    v_mfma_f32_16x16x32_bf16 v[28:31], a[148:151], v[136:139], v[28:31]
    s_waitcnt lgkmcnt(3)
    v_exp_f32 v162, v162
    v_mfma_f32_16x16x32_bf16 v[28:31], a[180:183], v[140:143], v[28:31]
    v_mfma_f32_16x16x32_bf16 v[32:35], a[152:155], v[136:139], v[32:35]
    v_exp_f32 v163, v163
    v_mfma_f32_16x16x32_bf16 v[32:35], a[184:187], v[140:143], v[32:35]
    s_waitcnt lgkmcnt(1)
    v_cvt_pk_bf16_f32 v157, v162, v163
    v_mfma_f32_16x16x32_bf16 v[36:39], a[156:159], v[136:139], v[36:39]
    s_waitcnt lgkmcnt(0)
    v_exp_f32 v164, v164
    v_mfma_f32_16x16x32_bf16 v[36:39], a[188:191], v[140:143], v[36:39]
    v_mfma_f32_16x16x32_bf16 v[136:139], a[64:67], a[32:35], v[208:211]
    v_mfma_f32_16x16x32_bf16 v[136:139], a[68:71], a[36:39], v[136:139]
    v_exp_f32 v165, v165
    v_mfma_f32_16x16x32_bf16 v[136:139], a[72:75], a[40:43], v[136:139]
    v_cvt_pk_bf16_f32 v158, v164, v165
    v_mfma_f32_16x16x32_bf16 v[136:139], a[76:79], a[44:47], v[136:139]
    v_exp_f32 v166, v166
    v_mfma_f32_16x16x32_bf16 v[140:143], a[92:95], a[44:47], v[208:211]
    s_nop 0
    v_mfma_f32_16x16x32_bf16 v[140:143], a[88:91], a[40:43], v[140:143]
    v_exp_f32 v167, v167
    v_mfma_f32_16x16x32_bf16 v[140:143], a[84:87], a[36:39], v[140:143]
    v_cvt_pk_bf16_f32 v159, v166, v167
    v_mfma_f32_16x16x32_bf16 v[140:143], a[80:83], a[32:35], v[140:143]
    s_add_u32 m0, s22, 0
    v_exp_f32 v136, v136
    v_mfma_f32_16x16x32_bf16 v[144:147], a[96:99], a[32:35], v[208:211]
    buffer_load_dwordx4 v232, s[12:15], s24 offen offset:0 lds
    v_mfma_f32_16x16x32_bf16 v[144:147], a[100:103], a[36:39], v[144:147]
    v_exp_f32 v137, v137
    v_mfma_f32_16x16x32_bf16 v[144:147], a[104:107], a[40:43], v[144:147]
    v_cvt_pk_bf16_f32 v136, v136, v137
    v_mfma_f32_16x16x32_bf16 v[144:147], a[108:111], a[44:47], v[144:147]
    v_exp_f32 v138, v138
    v_mfma_f32_16x16x32_bf16 v[148:151], a[124:127], a[44:47], v[208:211]
    buffer_load_dwordx4 v233, s[12:15], s24 offen offset:1024 lds
    v_mfma_f32_16x16x32_bf16 v[148:151], a[120:123], a[40:43], v[148:151]
    v_exp_f32 v139, v139
    v_mfma_f32_16x16x32_bf16 v[148:151], a[116:119], a[36:39], v[148:151]
    v_cvt_pk_bf16_f32 v137, v138, v139
    v_mfma_f32_16x16x32_bf16 v[148:151], a[112:115], a[32:35], v[148:151]
    v_exp_f32 v140, v140
    v_smfmac_f32_16x16x64_bf16 a[196:199], a[208:211], v[152:159], v168
    buffer_load_dwordx4 v232, s[12:15], s24 offen offset:2048 lds
    v_mfma_f32_16x16x32_bf16 v[40:43], a[128:131], v[152:155], v[40:43]
    v_exp_f32 v141, v141
    v_mfma_f32_16x16x32_bf16 v[40:43], a[160:163], v[156:159], v[40:43]
    v_cvt_pk_bf16_f32 v138, v140, v141
    v_mfma_f32_16x16x32_bf16 v[44:47], a[132:135], v[152:155], v[44:47]
    v_exp_f32 v142, v142
    v_mfma_f32_16x16x32_bf16 v[44:47], a[164:167], v[156:159], v[44:47]
    buffer_load_dwordx4 v233, s[12:15], s24 offen offset:3072 lds
    v_mfma_f32_16x16x32_bf16 v[48:51], a[136:139], v[152:155], v[48:51]
    s_add_u32 s24, s24, 16384
    v_exp_f32 v143, v143
    v_mfma_f32_16x16x32_bf16 v[48:51], a[168:171], v[156:159], v[48:51]
    v_cvt_pk_bf16_f32 v139, v142, v143
    v_mfma_f32_16x16x32_bf16 v[52:55], a[140:143], v[152:155], v[52:55]
    v_exp_f32 v144, v144
    v_mfma_f32_16x16x32_bf16 v[52:55], a[172:175], v[156:159], v[52:55]
    v_mfma_f32_16x16x32_bf16 v[56:59], a[144:147], v[152:155], v[56:59]
    v_exp_f32 v145, v145
    v_mfma_f32_16x16x32_bf16 v[56:59], a[176:179], v[156:159], v[56:59]
    v_cvt_pk_bf16_f32 v140, v144, v145
    v_mfma_f32_16x16x32_bf16 v[60:63], a[148:151], v[152:155], v[60:63]
    v_exp_f32 v146, v146
    v_mfma_f32_16x16x32_bf16 v[60:63], a[180:183], v[156:159], v[60:63]
    v_mfma_f32_16x16x32_bf16 v[64:67], a[152:155], v[152:155], v[64:67]
    v_exp_f32 v147, v147
    v_mfma_f32_16x16x32_bf16 v[64:67], a[184:187], v[156:159], v[64:67]
    v_cvt_pk_bf16_f32 v141, v146, v147
    v_mfma_f32_16x16x32_bf16 v[68:71], a[156:159], v[152:155], v[68:71]
    v_exp_f32 v148, v148
    v_mfma_f32_16x16x32_bf16 v[68:71], a[188:191], v[156:159], v[68:71]
.p2align 6
L_loop:
    v_mfma_f32_16x16x32_bf16 v[152:155], a[64:67], a[48:51], v[212:215]
    s_waitcnt vmcnt(8)
    s_barrier
    v_mfma_f32_16x16x32_bf16 v[152:155], a[68:71], a[52:55], v[152:155]
    v_exp_f32 v149, v149
    v_mfma_f32_16x16x32_bf16 v[152:155], a[72:75], a[56:59], v[152:155]
    ds_read_b128 a[64:67], v216 offset:32768
    v_cvt_pk_bf16_f32 v142, v148, v149
    v_mfma_f32_16x16x32_bf16 v[152:155], a[76:79], a[60:63], v[152:155]
    v_exp_f32 v150, v150
    v_mfma_f32_16x16x32_bf16 v[156:159], a[92:95], a[60:63], v[212:215]
    ds_read_b128 a[68:71], v217 offset:32768
    ds_read_b128 a[72:75], v218 offset:32768
    v_mfma_f32_16x16x32_bf16 v[156:159], a[88:91], a[56:59], v[156:159]
    v_exp_f32 v151, v151
    v_mfma_f32_16x16x32_bf16 v[156:159], a[84:87], a[52:55], v[156:159]
    ds_read_b128 a[76:79], v219 offset:32768
    v_cvt_pk_bf16_f32 v143, v150, v151
    v_mfma_f32_16x16x32_bf16 v[156:159], a[80:83], a[48:51], v[156:159]
    v_exp_f32 v152, v152
    v_mfma_f32_16x16x32_bf16 v[160:163], a[96:99], a[48:51], v[212:215]
    ds_read_b128 a[92:95], v219 offset:36864
    ds_read_b128 a[88:91], v218 offset:36864
    v_mfma_f32_16x16x32_bf16 v[160:163], a[100:103], a[52:55], v[160:163]
    v_exp_f32 v153, v153
    v_mfma_f32_16x16x32_bf16 v[160:163], a[104:107], a[56:59], v[160:163]
    ds_read_b128 a[84:87], v217 offset:36864
    v_cvt_pk_bf16_f32 v152, v152, v153
    v_mfma_f32_16x16x32_bf16 v[160:163], a[108:111], a[60:63], v[160:163]
    v_exp_f32 v154, v154
    v_mfma_f32_16x16x32_bf16 v[164:167], a[124:127], a[60:63], v[212:215]
    ds_read_b128 a[80:83], v216 offset:36864
    ds_read_b128 a[96:99], v216 offset:40960
    v_mfma_f32_16x16x32_bf16 v[164:167], a[120:123], a[56:59], v[164:167]
    v_exp_f32 v155, v155
    v_mfma_f32_16x16x32_bf16 v[164:167], a[116:119], a[52:55], v[164:167]
    ds_read_b128 a[100:103], v217 offset:40960
    v_cvt_pk_bf16_f32 v153, v154, v155
    v_mfma_f32_16x16x32_bf16 v[164:167], a[112:115], a[48:51], v[164:167]
    v_exp_f32 v156, v156
    v_smfmac_f32_16x16x64_bf16 a[200:203], a[208:211], v[136:143], v168
    ds_read_b128 a[104:107], v218 offset:40960
    ds_read_b128 a[108:111], v219 offset:40960
    v_mfma_f32_16x16x32_bf16 v[72:75], a[128:131], v[136:139], v[72:75]
    v_exp_f32 v157, v157
    v_mfma_f32_16x16x32_bf16 v[72:75], a[160:163], v[140:143], v[72:75]
    ds_read_b128 a[124:127], v219 offset:45056
    v_cvt_pk_bf16_f32 v154, v156, v157
    v_mfma_f32_16x16x32_bf16 v[76:79], a[132:135], v[136:139], v[76:79]
    v_exp_f32 v158, v158
    v_mfma_f32_16x16x32_bf16 v[76:79], a[164:167], v[140:143], v[76:79]
    ds_read_b128 a[120:123], v218 offset:45056
    ds_read_b128 a[116:119], v217 offset:45056
    v_mfma_f32_16x16x32_bf16 v[80:83], a[136:139], v[136:139], v[80:83]
    v_exp_f32 v159, v159
    v_mfma_f32_16x16x32_bf16 v[80:83], a[168:171], v[140:143], v[80:83]
    ds_read_b128 a[112:115], v216 offset:45056
    v_cvt_pk_bf16_f32 v155, v158, v159
    v_mfma_f32_16x16x32_bf16 v[84:87], a[140:143], v[136:139], v[84:87]
    v_exp_f32 v160, v160
    v_mfma_f32_16x16x32_bf16 v[84:87], a[172:175], v[140:143], v[84:87]
    v_mfma_f32_16x16x32_bf16 v[88:91], a[144:147], v[136:139], v[88:91]
    v_exp_f32 v161, v161
    v_mfma_f32_16x16x32_bf16 v[88:91], a[176:179], v[140:143], v[88:91]
    v_cvt_pk_bf16_f32 v156, v160, v161
    v_mfma_f32_16x16x32_bf16 v[92:95], a[148:151], v[136:139], v[92:95]
    v_exp_f32 v162, v162
    v_mfma_f32_16x16x32_bf16 v[92:95], a[180:183], v[140:143], v[92:95]
    v_mfma_f32_16x16x32_bf16 v[96:99], a[152:155], v[136:139], v[96:99]
    v_exp_f32 v163, v163
    v_mfma_f32_16x16x32_bf16 v[96:99], a[184:187], v[140:143], v[96:99]
    v_cvt_pk_bf16_f32 v157, v162, v163
    v_mfma_f32_16x16x32_bf16 v[100:103], a[156:159], v[136:139], v[100:103]
    v_exp_f32 v164, v164
    v_mfma_f32_16x16x32_bf16 v[100:103], a[188:191], v[140:143], v[100:103]
    s_waitcnt lgkmcnt(0)
    v_mfma_f32_16x16x32_bf16 v[136:139], a[64:67], a[0:3], v[200:203]
    v_mfma_f32_16x16x32_bf16 v[136:139], a[68:71], a[4:7], v[136:139]
    v_exp_f32 v165, v165
    v_mfma_f32_16x16x32_bf16 v[136:139], a[72:75], a[8:11], v[136:139]
    v_cvt_pk_bf16_f32 v158, v164, v165
    v_mfma_f32_16x16x32_bf16 v[136:139], a[76:79], a[12:15], v[136:139]
    s_add_u32 m0, s21, 0
    v_exp_f32 v166, v166
    v_mfma_f32_16x16x32_bf16 v[140:143], a[92:95], a[12:15], v[200:203]
    buffer_load_dwordx4 v228, s[8:11], s23 offen offset:0 lds
    v_mfma_f32_16x16x32_bf16 v[140:143], a[88:91], a[8:11], v[140:143]
    v_exp_f32 v167, v167
    v_mfma_f32_16x16x32_bf16 v[140:143], a[84:87], a[4:7], v[140:143]
    v_cvt_pk_bf16_f32 v159, v166, v167
    v_mfma_f32_16x16x32_bf16 v[140:143], a[80:83], a[0:3], v[140:143]
    v_exp_f32 v136, v136
    v_mfma_f32_16x16x32_bf16 v[144:147], a[96:99], a[0:3], v[200:203]
    buffer_load_dwordx4 v229, s[8:11], s23 offen offset:1024 lds
    v_mfma_f32_16x16x32_bf16 v[144:147], a[100:103], a[4:7], v[144:147]
    v_exp_f32 v137, v137
    v_mfma_f32_16x16x32_bf16 v[144:147], a[104:107], a[8:11], v[144:147]
    v_cvt_pk_bf16_f32 v136, v136, v137
    v_mfma_f32_16x16x32_bf16 v[144:147], a[108:111], a[12:15], v[144:147]
    v_exp_f32 v138, v138
    v_mfma_f32_16x16x32_bf16 v[148:151], a[124:127], a[12:15], v[200:203]
    buffer_load_dwordx4 v230, s[8:11], s23 offen offset:2048 lds
    v_mfma_f32_16x16x32_bf16 v[148:151], a[120:123], a[8:11], v[148:151]
    v_exp_f32 v139, v139
    v_mfma_f32_16x16x32_bf16 v[148:151], a[116:119], a[4:7], v[148:151]
    v_cvt_pk_bf16_f32 v137, v138, v139
    v_mfma_f32_16x16x32_bf16 v[148:151], a[112:115], a[0:3], v[148:151]
    v_exp_f32 v140, v140
    v_smfmac_f32_16x16x64_bf16 a[204:207], a[208:211], v[152:159], v168
    buffer_load_dwordx4 v231, s[8:11], s23 offen offset:3072 lds
    v_mfma_f32_16x16x32_bf16 v[104:107], a[128:131], v[152:155], v[104:107]
    s_add_u32 s23, s23, 16384
    v_exp_f32 v141, v141
    v_mfma_f32_16x16x32_bf16 v[104:107], a[160:163], v[156:159], v[104:107]
    ds_read_b64_tr_b16 a[128:129], v220 offset:49152
    v_cvt_pk_bf16_f32 v138, v140, v141
    v_mfma_f32_16x16x32_bf16 v[108:111], a[132:135], v[152:155], v[108:111]
    v_exp_f32 v142, v142
    v_mfma_f32_16x16x32_bf16 v[108:111], a[164:167], v[156:159], v[108:111]
    ds_read_b64_tr_b16 a[130:131], v220 offset:53248
    ds_read_b64_tr_b16 a[160:161], v220 offset:57344
    v_mfma_f32_16x16x32_bf16 v[112:115], a[136:139], v[152:155], v[112:115]
    v_exp_f32 v143, v143
    v_mfma_f32_16x16x32_bf16 v[112:115], a[168:171], v[156:159], v[112:115]
    ds_read_b64_tr_b16 a[162:163], v220 offset:61440
    v_cvt_pk_bf16_f32 v139, v142, v143
    v_mfma_f32_16x16x32_bf16 v[116:119], a[140:143], v[152:155], v[116:119]
    v_exp_f32 v144, v144
    v_mfma_f32_16x16x32_bf16 v[116:119], a[172:175], v[156:159], v[116:119]
    ds_read_b64_tr_b16 a[132:133], v221 offset:49152
    ds_read_b64_tr_b16 a[134:135], v221 offset:53248
    v_mfma_f32_16x16x32_bf16 v[120:123], a[144:147], v[152:155], v[120:123]
    v_exp_f32 v145, v145
    v_mfma_f32_16x16x32_bf16 v[120:123], a[176:179], v[156:159], v[120:123]
    ds_read_b64_tr_b16 a[164:165], v221 offset:57344
    v_cvt_pk_bf16_f32 v140, v144, v145
    v_mfma_f32_16x16x32_bf16 v[124:127], a[148:151], v[152:155], v[124:127]
    v_exp_f32 v146, v146
    v_mfma_f32_16x16x32_bf16 v[124:127], a[180:183], v[156:159], v[124:127]
    ds_read_b64_tr_b16 a[166:167], v221 offset:61440
    ds_read_b64_tr_b16 a[136:137], v222 offset:49152
    v_mfma_f32_16x16x32_bf16 v[128:131], a[152:155], v[152:155], v[128:131]
    v_exp_f32 v147, v147
    v_mfma_f32_16x16x32_bf16 v[128:131], a[184:187], v[156:159], v[128:131]
    ds_read_b64_tr_b16 a[138:139], v222 offset:53248
    v_cvt_pk_bf16_f32 v141, v146, v147
    v_mfma_f32_16x16x32_bf16 v[132:135], a[156:159], v[152:155], v[132:135]
    v_exp_f32 v148, v148
    v_mfma_f32_16x16x32_bf16 v[132:135], a[188:191], v[156:159], v[132:135]
    ds_read_b64_tr_b16 a[168:169], v222 offset:57344
    ds_read_b64_tr_b16 a[170:171], v222 offset:61440
    v_mfma_f32_16x16x32_bf16 v[152:155], a[64:67], a[16:19], v[204:207]
    ds_read_b64_tr_b16 a[140:141], v223 offset:49152
    v_mfma_f32_16x16x32_bf16 v[152:155], a[68:71], a[20:23], v[152:155]
    v_exp_f32 v149, v149
    v_mfma_f32_16x16x32_bf16 v[152:155], a[72:75], a[24:27], v[152:155]
    ds_read_b64_tr_b16 a[142:143], v223 offset:53248
    v_cvt_pk_bf16_f32 v142, v148, v149
    v_mfma_f32_16x16x32_bf16 v[152:155], a[76:79], a[28:31], v[152:155]
    v_exp_f32 v150, v150
    v_mfma_f32_16x16x32_bf16 v[156:159], a[92:95], a[28:31], v[204:207]
    ds_read_b64_tr_b16 a[172:173], v223 offset:57344
    ds_read_b64_tr_b16 a[174:175], v223 offset:61440
    v_mfma_f32_16x16x32_bf16 v[156:159], a[88:91], a[24:27], v[156:159]
    v_exp_f32 v151, v151
    v_mfma_f32_16x16x32_bf16 v[156:159], a[84:87], a[20:23], v[156:159]
    ds_read_b64_tr_b16 a[144:145], v224 offset:49152
    v_cvt_pk_bf16_f32 v143, v150, v151
    v_mfma_f32_16x16x32_bf16 v[156:159], a[80:83], a[16:19], v[156:159]
    v_exp_f32 v152, v152
    v_mfma_f32_16x16x32_bf16 v[160:163], a[96:99], a[16:19], v[204:207]
    ds_read_b64_tr_b16 a[146:147], v224 offset:53248
    ds_read_b64_tr_b16 a[176:177], v224 offset:57344
    v_mfma_f32_16x16x32_bf16 v[160:163], a[100:103], a[20:23], v[160:163]
    v_exp_f32 v153, v153
    v_mfma_f32_16x16x32_bf16 v[160:163], a[104:107], a[24:27], v[160:163]
    ds_read_b64_tr_b16 a[178:179], v224 offset:61440
    v_cvt_pk_bf16_f32 v152, v152, v153
    v_mfma_f32_16x16x32_bf16 v[160:163], a[108:111], a[28:31], v[160:163]
    v_exp_f32 v154, v154
    v_mfma_f32_16x16x32_bf16 v[164:167], a[124:127], a[28:31], v[204:207]
    ds_read_b64_tr_b16 a[148:149], v225 offset:49152
    ds_read_b64_tr_b16 a[150:151], v225 offset:53248
    v_mfma_f32_16x16x32_bf16 v[164:167], a[120:123], a[24:27], v[164:167]
    v_exp_f32 v155, v155
    v_mfma_f32_16x16x32_bf16 v[164:167], a[116:119], a[20:23], v[164:167]
    ds_read_b64_tr_b16 a[180:181], v225 offset:57344
    v_cvt_pk_bf16_f32 v153, v154, v155
    v_mfma_f32_16x16x32_bf16 v[164:167], a[112:115], a[16:19], v[164:167]
    v_exp_f32 v156, v156
    v_smfmac_f32_16x16x64_bf16 a[192:195], a[208:211], v[136:143], v168
    s_waitcnt lgkmcnt(2)
    ds_read_b64_tr_b16 a[182:183], v225 offset:61440
    ds_read_b64_tr_b16 a[152:153], v226 offset:49152
    v_mfma_f32_16x16x32_bf16 v[8:11], a[128:131], v[136:139], v[8:11]
    v_exp_f32 v157, v157
    v_mfma_f32_16x16x32_bf16 v[8:11], a[160:163], v[140:143], v[8:11]
    ds_read_b64_tr_b16 a[154:155], v226 offset:53248
    v_cvt_pk_bf16_f32 v154, v156, v157
    v_mfma_f32_16x16x32_bf16 v[12:15], a[132:135], v[136:139], v[12:15]
    v_exp_f32 v158, v158
    v_mfma_f32_16x16x32_bf16 v[12:15], a[164:167], v[140:143], v[12:15]
    ds_read_b64_tr_b16 a[184:185], v226 offset:57344
    ds_read_b64_tr_b16 a[186:187], v226 offset:61440
    v_mfma_f32_16x16x32_bf16 v[16:19], a[136:139], v[136:139], v[16:19]
    v_exp_f32 v159, v159
    v_mfma_f32_16x16x32_bf16 v[16:19], a[168:171], v[140:143], v[16:19]
    ds_read_b64_tr_b16 a[156:157], v227 offset:49152
    v_cvt_pk_bf16_f32 v155, v158, v159
    v_mfma_f32_16x16x32_bf16 v[20:23], a[140:143], v[136:139], v[20:23]
    v_exp_f32 v160, v160
    v_mfma_f32_16x16x32_bf16 v[20:23], a[172:175], v[140:143], v[20:23]
    ds_read_b64_tr_b16 a[158:159], v227 offset:53248
    ds_read_b64_tr_b16 a[188:189], v227 offset:57344
    v_mfma_f32_16x16x32_bf16 v[24:27], a[144:147], v[136:139], v[24:27]
    v_exp_f32 v161, v161
    v_mfma_f32_16x16x32_bf16 v[24:27], a[176:179], v[140:143], v[24:27]
    s_waitcnt lgkmcnt(2)
    ds_read_b64_tr_b16 a[190:191], v227 offset:61440
    v_cvt_pk_bf16_f32 v156, v160, v161
    v_mfma_f32_16x16x32_bf16 v[28:31], a[148:151], v[136:139], v[28:31]
    v_exp_f32 v162, v162
    v_mfma_f32_16x16x32_bf16 v[28:31], a[180:183], v[140:143], v[28:31]
    v_mfma_f32_16x16x32_bf16 v[32:35], a[152:155], v[136:139], v[32:35]
    v_exp_f32 v163, v163
    v_mfma_f32_16x16x32_bf16 v[32:35], a[184:187], v[140:143], v[32:35]
    s_waitcnt lgkmcnt(1)
    v_cvt_pk_bf16_f32 v157, v162, v163
    v_mfma_f32_16x16x32_bf16 v[36:39], a[156:159], v[136:139], v[36:39]
    s_waitcnt lgkmcnt(0)
    v_exp_f32 v164, v164
    v_mfma_f32_16x16x32_bf16 v[36:39], a[188:191], v[140:143], v[36:39]
    v_mfma_f32_16x16x32_bf16 v[136:139], a[64:67], a[32:35], v[208:211]
    v_mfma_f32_16x16x32_bf16 v[136:139], a[68:71], a[36:39], v[136:139]
    v_exp_f32 v165, v165
    v_mfma_f32_16x16x32_bf16 v[136:139], a[72:75], a[40:43], v[136:139]
    v_cvt_pk_bf16_f32 v158, v164, v165
    v_mfma_f32_16x16x32_bf16 v[136:139], a[76:79], a[44:47], v[136:139]
    v_exp_f32 v166, v166
    v_mfma_f32_16x16x32_bf16 v[140:143], a[92:95], a[44:47], v[208:211]
    s_nop 0
    v_mfma_f32_16x16x32_bf16 v[140:143], a[88:91], a[40:43], v[140:143]
    v_exp_f32 v167, v167
    v_mfma_f32_16x16x32_bf16 v[140:143], a[84:87], a[36:39], v[140:143]
    v_cvt_pk_bf16_f32 v159, v166, v167
    v_mfma_f32_16x16x32_bf16 v[140:143], a[80:83], a[32:35], v[140:143]
    s_add_u32 m0, s22, 16384
    v_exp_f32 v136, v136
    v_mfma_f32_16x16x32_bf16 v[144:147], a[96:99], a[32:35], v[208:211]
    buffer_load_dwordx4 v232, s[12:15], s24 offen offset:0 lds
    v_mfma_f32_16x16x32_bf16 v[144:147], a[100:103], a[36:39], v[144:147]
    v_exp_f32 v137, v137
    v_mfma_f32_16x16x32_bf16 v[144:147], a[104:107], a[40:43], v[144:147]
    v_cvt_pk_bf16_f32 v136, v136, v137
    v_mfma_f32_16x16x32_bf16 v[144:147], a[108:111], a[44:47], v[144:147]
    v_exp_f32 v138, v138
    v_mfma_f32_16x16x32_bf16 v[148:151], a[124:127], a[44:47], v[208:211]
    buffer_load_dwordx4 v233, s[12:15], s24 offen offset:1024 lds
    v_mfma_f32_16x16x32_bf16 v[148:151], a[120:123], a[40:43], v[148:151]
    v_exp_f32 v139, v139
    v_mfma_f32_16x16x32_bf16 v[148:151], a[116:119], a[36:39], v[148:151]
    v_cvt_pk_bf16_f32 v137, v138, v139
    v_mfma_f32_16x16x32_bf16 v[148:151], a[112:115], a[32:35], v[148:151]
    v_exp_f32 v140, v140
    v_smfmac_f32_16x16x64_bf16 a[196:199], a[208:211], v[152:159], v168
    buffer_load_dwordx4 v232, s[12:15], s24 offen offset:2048 lds
    v_mfma_f32_16x16x32_bf16 v[40:43], a[128:131], v[152:155], v[40:43]
    v_exp_f32 v141, v141
    v_mfma_f32_16x16x32_bf16 v[40:43], a[160:163], v[156:159], v[40:43]
    v_cvt_pk_bf16_f32 v138, v140, v141
    v_mfma_f32_16x16x32_bf16 v[44:47], a[132:135], v[152:155], v[44:47]
    v_exp_f32 v142, v142
    v_mfma_f32_16x16x32_bf16 v[44:47], a[164:167], v[156:159], v[44:47]
    buffer_load_dwordx4 v233, s[12:15], s24 offen offset:3072 lds
    v_mfma_f32_16x16x32_bf16 v[48:51], a[136:139], v[152:155], v[48:51]
    s_add_u32 s24, s24, 16384
    v_exp_f32 v143, v143
    v_mfma_f32_16x16x32_bf16 v[48:51], a[168:171], v[156:159], v[48:51]
    v_cvt_pk_bf16_f32 v139, v142, v143
    v_mfma_f32_16x16x32_bf16 v[52:55], a[140:143], v[152:155], v[52:55]
    v_exp_f32 v144, v144
    v_mfma_f32_16x16x32_bf16 v[52:55], a[172:175], v[156:159], v[52:55]
    v_mfma_f32_16x16x32_bf16 v[56:59], a[144:147], v[152:155], v[56:59]
    v_exp_f32 v145, v145
    v_mfma_f32_16x16x32_bf16 v[56:59], a[176:179], v[156:159], v[56:59]
    v_cvt_pk_bf16_f32 v140, v144, v145
    v_mfma_f32_16x16x32_bf16 v[60:63], a[148:151], v[152:155], v[60:63]
    v_exp_f32 v146, v146
    v_mfma_f32_16x16x32_bf16 v[60:63], a[180:183], v[156:159], v[60:63]
    v_mfma_f32_16x16x32_bf16 v[64:67], a[152:155], v[152:155], v[64:67]
    v_exp_f32 v147, v147
    v_mfma_f32_16x16x32_bf16 v[64:67], a[184:187], v[156:159], v[64:67]
    v_cvt_pk_bf16_f32 v141, v146, v147
    v_mfma_f32_16x16x32_bf16 v[68:71], a[156:159], v[152:155], v[68:71]
    v_exp_f32 v148, v148
    v_mfma_f32_16x16x32_bf16 v[68:71], a[188:191], v[156:159], v[68:71]
    v_mfma_f32_16x16x32_bf16 v[152:155], a[64:67], a[48:51], v[212:215]
    s_waitcnt vmcnt(8)
    s_barrier
    v_mfma_f32_16x16x32_bf16 v[152:155], a[68:71], a[52:55], v[152:155]
    v_exp_f32 v149, v149
    v_mfma_f32_16x16x32_bf16 v[152:155], a[72:75], a[56:59], v[152:155]
    ds_read_b128 a[64:67], v216 offset:49152
    v_cvt_pk_bf16_f32 v142, v148, v149
    v_mfma_f32_16x16x32_bf16 v[152:155], a[76:79], a[60:63], v[152:155]
    v_exp_f32 v150, v150
    v_mfma_f32_16x16x32_bf16 v[156:159], a[92:95], a[60:63], v[212:215]
    ds_read_b128 a[68:71], v217 offset:49152
    ds_read_b128 a[72:75], v218 offset:49152
    v_mfma_f32_16x16x32_bf16 v[156:159], a[88:91], a[56:59], v[156:159]
    v_exp_f32 v151, v151
    v_mfma_f32_16x16x32_bf16 v[156:159], a[84:87], a[52:55], v[156:159]
    ds_read_b128 a[76:79], v219 offset:49152
    v_cvt_pk_bf16_f32 v143, v150, v151
    v_mfma_f32_16x16x32_bf16 v[156:159], a[80:83], a[48:51], v[156:159]
    v_exp_f32 v152, v152
    v_mfma_f32_16x16x32_bf16 v[160:163], a[96:99], a[48:51], v[212:215]
    ds_read_b128 a[92:95], v219 offset:53248
    ds_read_b128 a[88:91], v218 offset:53248
    v_mfma_f32_16x16x32_bf16 v[160:163], a[100:103], a[52:55], v[160:163]
    v_exp_f32 v153, v153
    v_mfma_f32_16x16x32_bf16 v[160:163], a[104:107], a[56:59], v[160:163]
    ds_read_b128 a[84:87], v217 offset:53248
    v_cvt_pk_bf16_f32 v152, v152, v153
    v_mfma_f32_16x16x32_bf16 v[160:163], a[108:111], a[60:63], v[160:163]
    v_exp_f32 v154, v154
    v_mfma_f32_16x16x32_bf16 v[164:167], a[124:127], a[60:63], v[212:215]
    ds_read_b128 a[80:83], v216 offset:53248
    ds_read_b128 a[96:99], v216 offset:57344
    v_mfma_f32_16x16x32_bf16 v[164:167], a[120:123], a[56:59], v[164:167]
    v_exp_f32 v155, v155
    v_mfma_f32_16x16x32_bf16 v[164:167], a[116:119], a[52:55], v[164:167]
    ds_read_b128 a[100:103], v217 offset:57344
    v_cvt_pk_bf16_f32 v153, v154, v155
    v_mfma_f32_16x16x32_bf16 v[164:167], a[112:115], a[48:51], v[164:167]
    v_exp_f32 v156, v156
    v_smfmac_f32_16x16x64_bf16 a[200:203], a[208:211], v[136:143], v168
    ds_read_b128 a[104:107], v218 offset:57344
    ds_read_b128 a[108:111], v219 offset:57344
    v_mfma_f32_16x16x32_bf16 v[72:75], a[128:131], v[136:139], v[72:75]
    v_exp_f32 v157, v157
    v_mfma_f32_16x16x32_bf16 v[72:75], a[160:163], v[140:143], v[72:75]
    ds_read_b128 a[124:127], v219 offset:61440
    v_cvt_pk_bf16_f32 v154, v156, v157
    v_mfma_f32_16x16x32_bf16 v[76:79], a[132:135], v[136:139], v[76:79]
    v_exp_f32 v158, v158
    v_mfma_f32_16x16x32_bf16 v[76:79], a[164:167], v[140:143], v[76:79]
    ds_read_b128 a[120:123], v218 offset:61440
    ds_read_b128 a[116:119], v217 offset:61440
    v_mfma_f32_16x16x32_bf16 v[80:83], a[136:139], v[136:139], v[80:83]
    v_exp_f32 v159, v159
    v_mfma_f32_16x16x32_bf16 v[80:83], a[168:171], v[140:143], v[80:83]
    ds_read_b128 a[112:115], v216 offset:61440
    v_cvt_pk_bf16_f32 v155, v158, v159
    v_mfma_f32_16x16x32_bf16 v[84:87], a[140:143], v[136:139], v[84:87]
    v_exp_f32 v160, v160
    v_mfma_f32_16x16x32_bf16 v[84:87], a[172:175], v[140:143], v[84:87]
    v_mfma_f32_16x16x32_bf16 v[88:91], a[144:147], v[136:139], v[88:91]
    v_exp_f32 v161, v161
    v_mfma_f32_16x16x32_bf16 v[88:91], a[176:179], v[140:143], v[88:91]
    v_cvt_pk_bf16_f32 v156, v160, v161
    v_mfma_f32_16x16x32_bf16 v[92:95], a[148:151], v[136:139], v[92:95]
    v_exp_f32 v162, v162
    v_mfma_f32_16x16x32_bf16 v[92:95], a[180:183], v[140:143], v[92:95]
    v_mfma_f32_16x16x32_bf16 v[96:99], a[152:155], v[136:139], v[96:99]
    v_exp_f32 v163, v163
    v_mfma_f32_16x16x32_bf16 v[96:99], a[184:187], v[140:143], v[96:99]
    v_cvt_pk_bf16_f32 v157, v162, v163
    v_mfma_f32_16x16x32_bf16 v[100:103], a[156:159], v[136:139], v[100:103]
    v_exp_f32 v164, v164
    v_mfma_f32_16x16x32_bf16 v[100:103], a[188:191], v[140:143], v[100:103]
    s_waitcnt lgkmcnt(0)
    v_mfma_f32_16x16x32_bf16 v[136:139], a[64:67], a[0:3], v[200:203]
    v_mfma_f32_16x16x32_bf16 v[136:139], a[68:71], a[4:7], v[136:139]
    v_exp_f32 v165, v165
    v_mfma_f32_16x16x32_bf16 v[136:139], a[72:75], a[8:11], v[136:139]
    v_cvt_pk_bf16_f32 v158, v164, v165
    v_mfma_f32_16x16x32_bf16 v[136:139], a[76:79], a[12:15], v[136:139]
    s_add_u32 m0, s21, 16384
    v_exp_f32 v166, v166
    v_mfma_f32_16x16x32_bf16 v[140:143], a[92:95], a[12:15], v[200:203]
    buffer_load_dwordx4 v228, s[8:11], s23 offen offset:0 lds
    v_mfma_f32_16x16x32_bf16 v[140:143], a[88:91], a[8:11], v[140:143]
    v_exp_f32 v167, v167
    v_mfma_f32_16x16x32_bf16 v[140:143], a[84:87], a[4:7], v[140:143]
    v_cvt_pk_bf16_f32 v159, v166, v167
    v_mfma_f32_16x16x32_bf16 v[140:143], a[80:83], a[0:3], v[140:143]
    v_exp_f32 v136, v136
    v_mfma_f32_16x16x32_bf16 v[144:147], a[96:99], a[0:3], v[200:203]
    buffer_load_dwordx4 v229, s[8:11], s23 offen offset:1024 lds
    v_mfma_f32_16x16x32_bf16 v[144:147], a[100:103], a[4:7], v[144:147]
    v_exp_f32 v137, v137
    v_mfma_f32_16x16x32_bf16 v[144:147], a[104:107], a[8:11], v[144:147]
    v_cvt_pk_bf16_f32 v136, v136, v137
    v_mfma_f32_16x16x32_bf16 v[144:147], a[108:111], a[12:15], v[144:147]
    v_exp_f32 v138, v138
    v_mfma_f32_16x16x32_bf16 v[148:151], a[124:127], a[12:15], v[200:203]
    buffer_load_dwordx4 v230, s[8:11], s23 offen offset:2048 lds
    v_mfma_f32_16x16x32_bf16 v[148:151], a[120:123], a[8:11], v[148:151]
    v_exp_f32 v139, v139
    v_mfma_f32_16x16x32_bf16 v[148:151], a[116:119], a[4:7], v[148:151]
    v_cvt_pk_bf16_f32 v137, v138, v139
    v_mfma_f32_16x16x32_bf16 v[148:151], a[112:115], a[0:3], v[148:151]
    v_exp_f32 v140, v140
    v_smfmac_f32_16x16x64_bf16 a[204:207], a[208:211], v[152:159], v168
    buffer_load_dwordx4 v231, s[8:11], s23 offen offset:3072 lds
    v_mfma_f32_16x16x32_bf16 v[104:107], a[128:131], v[152:155], v[104:107]
    s_add_u32 s23, s23, 16384
    v_exp_f32 v141, v141
    v_mfma_f32_16x16x32_bf16 v[104:107], a[160:163], v[156:159], v[104:107]
    ds_read_b64_tr_b16 a[128:129], v220 offset:0
    v_cvt_pk_bf16_f32 v138, v140, v141
    v_mfma_f32_16x16x32_bf16 v[108:111], a[132:135], v[152:155], v[108:111]
    v_exp_f32 v142, v142
    v_mfma_f32_16x16x32_bf16 v[108:111], a[164:167], v[156:159], v[108:111]
    ds_read_b64_tr_b16 a[130:131], v220 offset:4096
    ds_read_b64_tr_b16 a[160:161], v220 offset:8192
    v_mfma_f32_16x16x32_bf16 v[112:115], a[136:139], v[152:155], v[112:115]
    v_exp_f32 v143, v143
    v_mfma_f32_16x16x32_bf16 v[112:115], a[168:171], v[156:159], v[112:115]
    ds_read_b64_tr_b16 a[162:163], v220 offset:12288
    v_cvt_pk_bf16_f32 v139, v142, v143
    v_mfma_f32_16x16x32_bf16 v[116:119], a[140:143], v[152:155], v[116:119]
    v_exp_f32 v144, v144
    v_mfma_f32_16x16x32_bf16 v[116:119], a[172:175], v[156:159], v[116:119]
    ds_read_b64_tr_b16 a[132:133], v221 offset:0
    ds_read_b64_tr_b16 a[134:135], v221 offset:4096
    v_mfma_f32_16x16x32_bf16 v[120:123], a[144:147], v[152:155], v[120:123]
    v_exp_f32 v145, v145
    v_mfma_f32_16x16x32_bf16 v[120:123], a[176:179], v[156:159], v[120:123]
    ds_read_b64_tr_b16 a[164:165], v221 offset:8192
    v_cvt_pk_bf16_f32 v140, v144, v145
    v_mfma_f32_16x16x32_bf16 v[124:127], a[148:151], v[152:155], v[124:127]
    v_exp_f32 v146, v146
    v_mfma_f32_16x16x32_bf16 v[124:127], a[180:183], v[156:159], v[124:127]
    ds_read_b64_tr_b16 a[166:167], v221 offset:12288
    ds_read_b64_tr_b16 a[136:137], v222 offset:0
    v_mfma_f32_16x16x32_bf16 v[128:131], a[152:155], v[152:155], v[128:131]
    v_exp_f32 v147, v147
    v_mfma_f32_16x16x32_bf16 v[128:131], a[184:187], v[156:159], v[128:131]
    ds_read_b64_tr_b16 a[138:139], v222 offset:4096
    v_cvt_pk_bf16_f32 v141, v146, v147
    v_mfma_f32_16x16x32_bf16 v[132:135], a[156:159], v[152:155], v[132:135]
    v_exp_f32 v148, v148
    v_mfma_f32_16x16x32_bf16 v[132:135], a[188:191], v[156:159], v[132:135]
    ds_read_b64_tr_b16 a[168:169], v222 offset:8192
    ds_read_b64_tr_b16 a[170:171], v222 offset:12288
    v_mfma_f32_16x16x32_bf16 v[152:155], a[64:67], a[16:19], v[204:207]
    ds_read_b64_tr_b16 a[140:141], v223 offset:0
    v_mfma_f32_16x16x32_bf16 v[152:155], a[68:71], a[20:23], v[152:155]
    v_exp_f32 v149, v149
    v_mfma_f32_16x16x32_bf16 v[152:155], a[72:75], a[24:27], v[152:155]
    ds_read_b64_tr_b16 a[142:143], v223 offset:4096
    v_cvt_pk_bf16_f32 v142, v148, v149
    v_mfma_f32_16x16x32_bf16 v[152:155], a[76:79], a[28:31], v[152:155]
    v_exp_f32 v150, v150
    v_mfma_f32_16x16x32_bf16 v[156:159], a[92:95], a[28:31], v[204:207]
    ds_read_b64_tr_b16 a[172:173], v223 offset:8192
    ds_read_b64_tr_b16 a[174:175], v223 offset:12288
    v_mfma_f32_16x16x32_bf16 v[156:159], a[88:91], a[24:27], v[156:159]
    v_exp_f32 v151, v151
    v_mfma_f32_16x16x32_bf16 v[156:159], a[84:87], a[20:23], v[156:159]
    ds_read_b64_tr_b16 a[144:145], v224 offset:0
    v_cvt_pk_bf16_f32 v143, v150, v151
    v_mfma_f32_16x16x32_bf16 v[156:159], a[80:83], a[16:19], v[156:159]
    v_exp_f32 v152, v152
    v_mfma_f32_16x16x32_bf16 v[160:163], a[96:99], a[16:19], v[204:207]
    ds_read_b64_tr_b16 a[146:147], v224 offset:4096
    ds_read_b64_tr_b16 a[176:177], v224 offset:8192
    v_mfma_f32_16x16x32_bf16 v[160:163], a[100:103], a[20:23], v[160:163]
    v_exp_f32 v153, v153
    v_mfma_f32_16x16x32_bf16 v[160:163], a[104:107], a[24:27], v[160:163]
    ds_read_b64_tr_b16 a[178:179], v224 offset:12288
    v_cvt_pk_bf16_f32 v152, v152, v153
    v_mfma_f32_16x16x32_bf16 v[160:163], a[108:111], a[28:31], v[160:163]
    v_exp_f32 v154, v154
    v_mfma_f32_16x16x32_bf16 v[164:167], a[124:127], a[28:31], v[204:207]
    ds_read_b64_tr_b16 a[148:149], v225 offset:0
    ds_read_b64_tr_b16 a[150:151], v225 offset:4096
    v_mfma_f32_16x16x32_bf16 v[164:167], a[120:123], a[24:27], v[164:167]
    v_exp_f32 v155, v155
    v_mfma_f32_16x16x32_bf16 v[164:167], a[116:119], a[20:23], v[164:167]
    ds_read_b64_tr_b16 a[180:181], v225 offset:8192
    v_cvt_pk_bf16_f32 v153, v154, v155
    v_mfma_f32_16x16x32_bf16 v[164:167], a[112:115], a[16:19], v[164:167]
    v_exp_f32 v156, v156
    v_smfmac_f32_16x16x64_bf16 a[192:195], a[208:211], v[136:143], v168
    s_waitcnt lgkmcnt(2)
    ds_read_b64_tr_b16 a[182:183], v225 offset:12288
    ds_read_b64_tr_b16 a[152:153], v226 offset:0
    v_mfma_f32_16x16x32_bf16 v[8:11], a[128:131], v[136:139], v[8:11]
    v_exp_f32 v157, v157
    v_mfma_f32_16x16x32_bf16 v[8:11], a[160:163], v[140:143], v[8:11]
    ds_read_b64_tr_b16 a[154:155], v226 offset:4096
    v_cvt_pk_bf16_f32 v154, v156, v157
    v_mfma_f32_16x16x32_bf16 v[12:15], a[132:135], v[136:139], v[12:15]
    v_exp_f32 v158, v158
    v_mfma_f32_16x16x32_bf16 v[12:15], a[164:167], v[140:143], v[12:15]
    ds_read_b64_tr_b16 a[184:185], v226 offset:8192
    ds_read_b64_tr_b16 a[186:187], v226 offset:12288
    v_mfma_f32_16x16x32_bf16 v[16:19], a[136:139], v[136:139], v[16:19]
    v_exp_f32 v159, v159
    v_mfma_f32_16x16x32_bf16 v[16:19], a[168:171], v[140:143], v[16:19]
    ds_read_b64_tr_b16 a[156:157], v227 offset:0
    v_cvt_pk_bf16_f32 v155, v158, v159
    v_mfma_f32_16x16x32_bf16 v[20:23], a[140:143], v[136:139], v[20:23]
    v_exp_f32 v160, v160
    v_mfma_f32_16x16x32_bf16 v[20:23], a[172:175], v[140:143], v[20:23]
    ds_read_b64_tr_b16 a[158:159], v227 offset:4096
    ds_read_b64_tr_b16 a[188:189], v227 offset:8192
    v_mfma_f32_16x16x32_bf16 v[24:27], a[144:147], v[136:139], v[24:27]
    v_exp_f32 v161, v161
    v_mfma_f32_16x16x32_bf16 v[24:27], a[176:179], v[140:143], v[24:27]
    s_waitcnt lgkmcnt(2)
    ds_read_b64_tr_b16 a[190:191], v227 offset:12288
    v_cvt_pk_bf16_f32 v156, v160, v161
    v_mfma_f32_16x16x32_bf16 v[28:31], a[148:151], v[136:139], v[28:31]
    v_exp_f32 v162, v162
    v_mfma_f32_16x16x32_bf16 v[28:31], a[180:183], v[140:143], v[28:31]
    v_mfma_f32_16x16x32_bf16 v[32:35], a[152:155], v[136:139], v[32:35]
    v_exp_f32 v163, v163
    v_mfma_f32_16x16x32_bf16 v[32:35], a[184:187], v[140:143], v[32:35]
    s_waitcnt lgkmcnt(1)
    v_cvt_pk_bf16_f32 v157, v162, v163
    v_mfma_f32_16x16x32_bf16 v[36:39], a[156:159], v[136:139], v[36:39]
    s_waitcnt lgkmcnt(0)
    v_exp_f32 v164, v164
    v_mfma_f32_16x16x32_bf16 v[36:39], a[188:191], v[140:143], v[36:39]
    v_mfma_f32_16x16x32_bf16 v[136:139], a[64:67], a[32:35], v[208:211]
    v_mfma_f32_16x16x32_bf16 v[136:139], a[68:71], a[36:39], v[136:139]
    v_exp_f32 v165, v165
    v_mfma_f32_16x16x32_bf16 v[136:139], a[72:75], a[40:43], v[136:139]
    v_cvt_pk_bf16_f32 v158, v164, v165
    v_mfma_f32_16x16x32_bf16 v[136:139], a[76:79], a[44:47], v[136:139]
    v_exp_f32 v166, v166
    v_mfma_f32_16x16x32_bf16 v[140:143], a[92:95], a[44:47], v[208:211]
    s_nop 0
    v_mfma_f32_16x16x32_bf16 v[140:143], a[88:91], a[40:43], v[140:143]
    v_exp_f32 v167, v167
    v_mfma_f32_16x16x32_bf16 v[140:143], a[84:87], a[36:39], v[140:143]
    v_cvt_pk_bf16_f32 v159, v166, v167
    v_mfma_f32_16x16x32_bf16 v[140:143], a[80:83], a[32:35], v[140:143]
    s_add_u32 m0, s22, 32768
    v_exp_f32 v136, v136
    v_mfma_f32_16x16x32_bf16 v[144:147], a[96:99], a[32:35], v[208:211]
    buffer_load_dwordx4 v232, s[12:15], s24 offen offset:0 lds
    v_mfma_f32_16x16x32_bf16 v[144:147], a[100:103], a[36:39], v[144:147]
    v_exp_f32 v137, v137
    v_mfma_f32_16x16x32_bf16 v[144:147], a[104:107], a[40:43], v[144:147]
    v_cvt_pk_bf16_f32 v136, v136, v137
    v_mfma_f32_16x16x32_bf16 v[144:147], a[108:111], a[44:47], v[144:147]
    v_exp_f32 v138, v138
    v_mfma_f32_16x16x32_bf16 v[148:151], a[124:127], a[44:47], v[208:211]
    buffer_load_dwordx4 v233, s[12:15], s24 offen offset:1024 lds
    v_mfma_f32_16x16x32_bf16 v[148:151], a[120:123], a[40:43], v[148:151]
    v_exp_f32 v139, v139
    v_mfma_f32_16x16x32_bf16 v[148:151], a[116:119], a[36:39], v[148:151]
    v_cvt_pk_bf16_f32 v137, v138, v139
    v_mfma_f32_16x16x32_bf16 v[148:151], a[112:115], a[32:35], v[148:151]
    v_exp_f32 v140, v140
    v_smfmac_f32_16x16x64_bf16 a[196:199], a[208:211], v[152:159], v168
    buffer_load_dwordx4 v232, s[12:15], s24 offen offset:2048 lds
    v_mfma_f32_16x16x32_bf16 v[40:43], a[128:131], v[152:155], v[40:43]
    v_exp_f32 v141, v141
    v_mfma_f32_16x16x32_bf16 v[40:43], a[160:163], v[156:159], v[40:43]
    v_cvt_pk_bf16_f32 v138, v140, v141
    v_mfma_f32_16x16x32_bf16 v[44:47], a[132:135], v[152:155], v[44:47]
    v_exp_f32 v142, v142
    v_mfma_f32_16x16x32_bf16 v[44:47], a[164:167], v[156:159], v[44:47]
    buffer_load_dwordx4 v233, s[12:15], s24 offen offset:3072 lds
    v_mfma_f32_16x16x32_bf16 v[48:51], a[136:139], v[152:155], v[48:51]
    s_add_u32 s24, s24, 16384
    v_exp_f32 v143, v143
    v_mfma_f32_16x16x32_bf16 v[48:51], a[168:171], v[156:159], v[48:51]
    v_cvt_pk_bf16_f32 v139, v142, v143
    v_mfma_f32_16x16x32_bf16 v[52:55], a[140:143], v[152:155], v[52:55]
    v_exp_f32 v144, v144
    v_mfma_f32_16x16x32_bf16 v[52:55], a[172:175], v[156:159], v[52:55]
    v_mfma_f32_16x16x32_bf16 v[56:59], a[144:147], v[152:155], v[56:59]
    v_exp_f32 v145, v145
    v_mfma_f32_16x16x32_bf16 v[56:59], a[176:179], v[156:159], v[56:59]
    v_cvt_pk_bf16_f32 v140, v144, v145
    v_mfma_f32_16x16x32_bf16 v[60:63], a[148:151], v[152:155], v[60:63]
    v_exp_f32 v146, v146
    v_mfma_f32_16x16x32_bf16 v[60:63], a[180:183], v[156:159], v[60:63]
    v_mfma_f32_16x16x32_bf16 v[64:67], a[152:155], v[152:155], v[64:67]
    v_exp_f32 v147, v147
    v_mfma_f32_16x16x32_bf16 v[64:67], a[184:187], v[156:159], v[64:67]
    v_cvt_pk_bf16_f32 v141, v146, v147
    v_mfma_f32_16x16x32_bf16 v[68:71], a[156:159], v[152:155], v[68:71]
    v_exp_f32 v148, v148
    v_mfma_f32_16x16x32_bf16 v[68:71], a[188:191], v[156:159], v[68:71]
    v_mfma_f32_16x16x32_bf16 v[152:155], a[64:67], a[48:51], v[212:215]
    s_waitcnt vmcnt(8)
    s_barrier
    v_mfma_f32_16x16x32_bf16 v[152:155], a[68:71], a[52:55], v[152:155]
    v_exp_f32 v149, v149
    v_mfma_f32_16x16x32_bf16 v[152:155], a[72:75], a[56:59], v[152:155]
    ds_read_b128 a[64:67], v216 offset:0
    v_cvt_pk_bf16_f32 v142, v148, v149
    v_mfma_f32_16x16x32_bf16 v[152:155], a[76:79], a[60:63], v[152:155]
    v_exp_f32 v150, v150
    v_mfma_f32_16x16x32_bf16 v[156:159], a[92:95], a[60:63], v[212:215]
    ds_read_b128 a[68:71], v217 offset:0
    ds_read_b128 a[72:75], v218 offset:0
    v_mfma_f32_16x16x32_bf16 v[156:159], a[88:91], a[56:59], v[156:159]
    v_exp_f32 v151, v151
    v_mfma_f32_16x16x32_bf16 v[156:159], a[84:87], a[52:55], v[156:159]
    ds_read_b128 a[76:79], v219 offset:0
    v_cvt_pk_bf16_f32 v143, v150, v151
    v_mfma_f32_16x16x32_bf16 v[156:159], a[80:83], a[48:51], v[156:159]
    v_exp_f32 v152, v152
    v_mfma_f32_16x16x32_bf16 v[160:163], a[96:99], a[48:51], v[212:215]
    ds_read_b128 a[92:95], v219 offset:4096
    ds_read_b128 a[88:91], v218 offset:4096
    v_mfma_f32_16x16x32_bf16 v[160:163], a[100:103], a[52:55], v[160:163]
    v_exp_f32 v153, v153
    v_mfma_f32_16x16x32_bf16 v[160:163], a[104:107], a[56:59], v[160:163]
    ds_read_b128 a[84:87], v217 offset:4096
    v_cvt_pk_bf16_f32 v152, v152, v153
    v_mfma_f32_16x16x32_bf16 v[160:163], a[108:111], a[60:63], v[160:163]
    v_exp_f32 v154, v154
    v_mfma_f32_16x16x32_bf16 v[164:167], a[124:127], a[60:63], v[212:215]
    ds_read_b128 a[80:83], v216 offset:4096
    ds_read_b128 a[96:99], v216 offset:8192
    v_mfma_f32_16x16x32_bf16 v[164:167], a[120:123], a[56:59], v[164:167]
    v_exp_f32 v155, v155
    v_mfma_f32_16x16x32_bf16 v[164:167], a[116:119], a[52:55], v[164:167]
    ds_read_b128 a[100:103], v217 offset:8192
    v_cvt_pk_bf16_f32 v153, v154, v155
    v_mfma_f32_16x16x32_bf16 v[164:167], a[112:115], a[48:51], v[164:167]
    v_exp_f32 v156, v156
    v_smfmac_f32_16x16x64_bf16 a[200:203], a[208:211], v[136:143], v168
    ds_read_b128 a[104:107], v218 offset:8192
    ds_read_b128 a[108:111], v219 offset:8192
    v_mfma_f32_16x16x32_bf16 v[72:75], a[128:131], v[136:139], v[72:75]
    v_exp_f32 v157, v157
    v_mfma_f32_16x16x32_bf16 v[72:75], a[160:163], v[140:143], v[72:75]
    ds_read_b128 a[124:127], v219 offset:12288
    v_cvt_pk_bf16_f32 v154, v156, v157
    v_mfma_f32_16x16x32_bf16 v[76:79], a[132:135], v[136:139], v[76:79]
    v_exp_f32 v158, v158
    v_mfma_f32_16x16x32_bf16 v[76:79], a[164:167], v[140:143], v[76:79]
    ds_read_b128 a[120:123], v218 offset:12288
    ds_read_b128 a[116:119], v217 offset:12288
    v_mfma_f32_16x16x32_bf16 v[80:83], a[136:139], v[136:139], v[80:83]
    v_exp_f32 v159, v159
    v_mfma_f32_16x16x32_bf16 v[80:83], a[168:171], v[140:143], v[80:83]
    ds_read_b128 a[112:115], v216 offset:12288
    v_cvt_pk_bf16_f32 v155, v158, v159
    v_mfma_f32_16x16x32_bf16 v[84:87], a[140:143], v[136:139], v[84:87]
    v_exp_f32 v160, v160
    v_mfma_f32_16x16x32_bf16 v[84:87], a[172:175], v[140:143], v[84:87]
    v_mfma_f32_16x16x32_bf16 v[88:91], a[144:147], v[136:139], v[88:91]
    v_exp_f32 v161, v161
    v_mfma_f32_16x16x32_bf16 v[88:91], a[176:179], v[140:143], v[88:91]
    v_cvt_pk_bf16_f32 v156, v160, v161
    v_mfma_f32_16x16x32_bf16 v[92:95], a[148:151], v[136:139], v[92:95]
    v_exp_f32 v162, v162
    v_mfma_f32_16x16x32_bf16 v[92:95], a[180:183], v[140:143], v[92:95]
    v_mfma_f32_16x16x32_bf16 v[96:99], a[152:155], v[136:139], v[96:99]
    v_exp_f32 v163, v163
    v_mfma_f32_16x16x32_bf16 v[96:99], a[184:187], v[140:143], v[96:99]
    v_cvt_pk_bf16_f32 v157, v162, v163
    v_mfma_f32_16x16x32_bf16 v[100:103], a[156:159], v[136:139], v[100:103]
    v_exp_f32 v164, v164
    v_mfma_f32_16x16x32_bf16 v[100:103], a[188:191], v[140:143], v[100:103]
    s_waitcnt lgkmcnt(0)
    v_mfma_f32_16x16x32_bf16 v[136:139], a[64:67], a[0:3], v[200:203]
    v_mfma_f32_16x16x32_bf16 v[136:139], a[68:71], a[4:7], v[136:139]
    v_exp_f32 v165, v165
    v_mfma_f32_16x16x32_bf16 v[136:139], a[72:75], a[8:11], v[136:139]
    v_cvt_pk_bf16_f32 v158, v164, v165
    v_mfma_f32_16x16x32_bf16 v[136:139], a[76:79], a[12:15], v[136:139]
    s_add_u32 m0, s21, 32768
    v_exp_f32 v166, v166
    v_mfma_f32_16x16x32_bf16 v[140:143], a[92:95], a[12:15], v[200:203]
    buffer_load_dwordx4 v228, s[8:11], s23 offen offset:0 lds
    v_mfma_f32_16x16x32_bf16 v[140:143], a[88:91], a[8:11], v[140:143]
    v_exp_f32 v167, v167
    v_mfma_f32_16x16x32_bf16 v[140:143], a[84:87], a[4:7], v[140:143]
    v_cvt_pk_bf16_f32 v159, v166, v167
    v_mfma_f32_16x16x32_bf16 v[140:143], a[80:83], a[0:3], v[140:143]
    v_exp_f32 v136, v136
    v_mfma_f32_16x16x32_bf16 v[144:147], a[96:99], a[0:3], v[200:203]
    buffer_load_dwordx4 v229, s[8:11], s23 offen offset:1024 lds
    v_mfma_f32_16x16x32_bf16 v[144:147], a[100:103], a[4:7], v[144:147]
    v_exp_f32 v137, v137
    v_mfma_f32_16x16x32_bf16 v[144:147], a[104:107], a[8:11], v[144:147]
    v_cvt_pk_bf16_f32 v136, v136, v137
    v_mfma_f32_16x16x32_bf16 v[144:147], a[108:111], a[12:15], v[144:147]
    v_exp_f32 v138, v138
    v_mfma_f32_16x16x32_bf16 v[148:151], a[124:127], a[12:15], v[200:203]
    buffer_load_dwordx4 v230, s[8:11], s23 offen offset:2048 lds
    v_mfma_f32_16x16x32_bf16 v[148:151], a[120:123], a[8:11], v[148:151]
    v_exp_f32 v139, v139
    v_mfma_f32_16x16x32_bf16 v[148:151], a[116:119], a[4:7], v[148:151]
    v_cvt_pk_bf16_f32 v137, v138, v139
    v_mfma_f32_16x16x32_bf16 v[148:151], a[112:115], a[0:3], v[148:151]
    v_exp_f32 v140, v140
    v_smfmac_f32_16x16x64_bf16 a[204:207], a[208:211], v[152:159], v168
    buffer_load_dwordx4 v231, s[8:11], s23 offen offset:3072 lds
    v_mfma_f32_16x16x32_bf16 v[104:107], a[128:131], v[152:155], v[104:107]
    s_add_u32 s23, s23, 16384
    v_exp_f32 v141, v141
    v_mfma_f32_16x16x32_bf16 v[104:107], a[160:163], v[156:159], v[104:107]
    ds_read_b64_tr_b16 a[128:129], v220 offset:16384
    v_cvt_pk_bf16_f32 v138, v140, v141
    v_mfma_f32_16x16x32_bf16 v[108:111], a[132:135], v[152:155], v[108:111]
    v_exp_f32 v142, v142
    v_mfma_f32_16x16x32_bf16 v[108:111], a[164:167], v[156:159], v[108:111]
    ds_read_b64_tr_b16 a[130:131], v220 offset:20480
    ds_read_b64_tr_b16 a[160:161], v220 offset:24576
    v_mfma_f32_16x16x32_bf16 v[112:115], a[136:139], v[152:155], v[112:115]
    v_exp_f32 v143, v143
    v_mfma_f32_16x16x32_bf16 v[112:115], a[168:171], v[156:159], v[112:115]
    ds_read_b64_tr_b16 a[162:163], v220 offset:28672
    v_cvt_pk_bf16_f32 v139, v142, v143
    v_mfma_f32_16x16x32_bf16 v[116:119], a[140:143], v[152:155], v[116:119]
    v_exp_f32 v144, v144
    v_mfma_f32_16x16x32_bf16 v[116:119], a[172:175], v[156:159], v[116:119]
    ds_read_b64_tr_b16 a[132:133], v221 offset:16384
    ds_read_b64_tr_b16 a[134:135], v221 offset:20480
    v_mfma_f32_16x16x32_bf16 v[120:123], a[144:147], v[152:155], v[120:123]
    v_exp_f32 v145, v145
    v_mfma_f32_16x16x32_bf16 v[120:123], a[176:179], v[156:159], v[120:123]
    ds_read_b64_tr_b16 a[164:165], v221 offset:24576
    v_cvt_pk_bf16_f32 v140, v144, v145
    v_mfma_f32_16x16x32_bf16 v[124:127], a[148:151], v[152:155], v[124:127]
    v_exp_f32 v146, v146
    v_mfma_f32_16x16x32_bf16 v[124:127], a[180:183], v[156:159], v[124:127]
    ds_read_b64_tr_b16 a[166:167], v221 offset:28672
    ds_read_b64_tr_b16 a[136:137], v222 offset:16384
    v_mfma_f32_16x16x32_bf16 v[128:131], a[152:155], v[152:155], v[128:131]
    v_exp_f32 v147, v147
    v_mfma_f32_16x16x32_bf16 v[128:131], a[184:187], v[156:159], v[128:131]
    ds_read_b64_tr_b16 a[138:139], v222 offset:20480
    v_cvt_pk_bf16_f32 v141, v146, v147
    v_mfma_f32_16x16x32_bf16 v[132:135], a[156:159], v[152:155], v[132:135]
    v_exp_f32 v148, v148
    v_mfma_f32_16x16x32_bf16 v[132:135], a[188:191], v[156:159], v[132:135]
    ds_read_b64_tr_b16 a[168:169], v222 offset:24576
    ds_read_b64_tr_b16 a[170:171], v222 offset:28672
    v_mfma_f32_16x16x32_bf16 v[152:155], a[64:67], a[16:19], v[204:207]
    ds_read_b64_tr_b16 a[140:141], v223 offset:16384
    v_mfma_f32_16x16x32_bf16 v[152:155], a[68:71], a[20:23], v[152:155]
    v_exp_f32 v149, v149
    v_mfma_f32_16x16x32_bf16 v[152:155], a[72:75], a[24:27], v[152:155]
    ds_read_b64_tr_b16 a[142:143], v223 offset:20480
    v_cvt_pk_bf16_f32 v142, v148, v149
    v_mfma_f32_16x16x32_bf16 v[152:155], a[76:79], a[28:31], v[152:155]
    v_exp_f32 v150, v150
    v_mfma_f32_16x16x32_bf16 v[156:159], a[92:95], a[28:31], v[204:207]
    ds_read_b64_tr_b16 a[172:173], v223 offset:24576
    ds_read_b64_tr_b16 a[174:175], v223 offset:28672
    v_mfma_f32_16x16x32_bf16 v[156:159], a[88:91], a[24:27], v[156:159]
    v_exp_f32 v151, v151
    v_mfma_f32_16x16x32_bf16 v[156:159], a[84:87], a[20:23], v[156:159]
    ds_read_b64_tr_b16 a[144:145], v224 offset:16384
    v_cvt_pk_bf16_f32 v143, v150, v151
    v_mfma_f32_16x16x32_bf16 v[156:159], a[80:83], a[16:19], v[156:159]
    v_exp_f32 v152, v152
    v_mfma_f32_16x16x32_bf16 v[160:163], a[96:99], a[16:19], v[204:207]
    ds_read_b64_tr_b16 a[146:147], v224 offset:20480
    ds_read_b64_tr_b16 a[176:177], v224 offset:24576
    v_mfma_f32_16x16x32_bf16 v[160:163], a[100:103], a[20:23], v[160:163]
    v_exp_f32 v153, v153
    v_mfma_f32_16x16x32_bf16 v[160:163], a[104:107], a[24:27], v[160:163]
    ds_read_b64_tr_b16 a[178:179], v224 offset:28672
    v_cvt_pk_bf16_f32 v152, v152, v153
    v_mfma_f32_16x16x32_bf16 v[160:163], a[108:111], a[28:31], v[160:163]
    v_exp_f32 v154, v154
    v_mfma_f32_16x16x32_bf16 v[164:167], a[124:127], a[28:31], v[204:207]
    ds_read_b64_tr_b16 a[148:149], v225 offset:16384
    ds_read_b64_tr_b16 a[150:151], v225 offset:20480
    v_mfma_f32_16x16x32_bf16 v[164:167], a[120:123], a[24:27], v[164:167]
    v_exp_f32 v155, v155
    v_mfma_f32_16x16x32_bf16 v[164:167], a[116:119], a[20:23], v[164:167]
    ds_read_b64_tr_b16 a[180:181], v225 offset:24576
    v_cvt_pk_bf16_f32 v153, v154, v155
    v_mfma_f32_16x16x32_bf16 v[164:167], a[112:115], a[16:19], v[164:167]
    v_exp_f32 v156, v156
    v_smfmac_f32_16x16x64_bf16 a[192:195], a[208:211], v[136:143], v168
    s_waitcnt lgkmcnt(2)
    ds_read_b64_tr_b16 a[182:183], v225 offset:28672
    ds_read_b64_tr_b16 a[152:153], v226 offset:16384
    v_mfma_f32_16x16x32_bf16 v[8:11], a[128:131], v[136:139], v[8:11]
    v_exp_f32 v157, v157
    v_mfma_f32_16x16x32_bf16 v[8:11], a[160:163], v[140:143], v[8:11]
    ds_read_b64_tr_b16 a[154:155], v226 offset:20480
    v_cvt_pk_bf16_f32 v154, v156, v157
    v_mfma_f32_16x16x32_bf16 v[12:15], a[132:135], v[136:139], v[12:15]
    v_exp_f32 v158, v158
    v_mfma_f32_16x16x32_bf16 v[12:15], a[164:167], v[140:143], v[12:15]
    ds_read_b64_tr_b16 a[184:185], v226 offset:24576
    ds_read_b64_tr_b16 a[186:187], v226 offset:28672
    v_mfma_f32_16x16x32_bf16 v[16:19], a[136:139], v[136:139], v[16:19]
    v_exp_f32 v159, v159
    v_mfma_f32_16x16x32_bf16 v[16:19], a[168:171], v[140:143], v[16:19]
    ds_read_b64_tr_b16 a[156:157], v227 offset:16384
    v_cvt_pk_bf16_f32 v155, v158, v159
    v_mfma_f32_16x16x32_bf16 v[20:23], a[140:143], v[136:139], v[20:23]
    v_exp_f32 v160, v160
    v_mfma_f32_16x16x32_bf16 v[20:23], a[172:175], v[140:143], v[20:23]
    ds_read_b64_tr_b16 a[158:159], v227 offset:20480
    ds_read_b64_tr_b16 a[188:189], v227 offset:24576
    v_mfma_f32_16x16x32_bf16 v[24:27], a[144:147], v[136:139], v[24:27]
    v_exp_f32 v161, v161
    v_mfma_f32_16x16x32_bf16 v[24:27], a[176:179], v[140:143], v[24:27]
    s_waitcnt lgkmcnt(2)
    ds_read_b64_tr_b16 a[190:191], v227 offset:28672
    v_cvt_pk_bf16_f32 v156, v160, v161
    v_mfma_f32_16x16x32_bf16 v[28:31], a[148:151], v[136:139], v[28:31]
    v_exp_f32 v162, v162
    v_mfma_f32_16x16x32_bf16 v[28:31], a[180:183], v[140:143], v[28:31]
    v_mfma_f32_16x16x32_bf16 v[32:35], a[152:155], v[136:139], v[32:35]
    v_exp_f32 v163, v163
    v_mfma_f32_16x16x32_bf16 v[32:35], a[184:187], v[140:143], v[32:35]
    s_waitcnt lgkmcnt(1)
    v_cvt_pk_bf16_f32 v157, v162, v163
    v_mfma_f32_16x16x32_bf16 v[36:39], a[156:159], v[136:139], v[36:39]
    s_waitcnt lgkmcnt(0)
    v_exp_f32 v164, v164
    v_mfma_f32_16x16x32_bf16 v[36:39], a[188:191], v[140:143], v[36:39]
    v_mfma_f32_16x16x32_bf16 v[136:139], a[64:67], a[32:35], v[208:211]
    v_mfma_f32_16x16x32_bf16 v[136:139], a[68:71], a[36:39], v[136:139]
    v_exp_f32 v165, v165
    v_mfma_f32_16x16x32_bf16 v[136:139], a[72:75], a[40:43], v[136:139]
    v_cvt_pk_bf16_f32 v158, v164, v165
    v_mfma_f32_16x16x32_bf16 v[136:139], a[76:79], a[44:47], v[136:139]
    v_exp_f32 v166, v166
    v_mfma_f32_16x16x32_bf16 v[140:143], a[92:95], a[44:47], v[208:211]
    s_nop 0
    v_mfma_f32_16x16x32_bf16 v[140:143], a[88:91], a[40:43], v[140:143]
    v_exp_f32 v167, v167
    v_mfma_f32_16x16x32_bf16 v[140:143], a[84:87], a[36:39], v[140:143]
    v_cvt_pk_bf16_f32 v159, v166, v167
    v_mfma_f32_16x16x32_bf16 v[140:143], a[80:83], a[32:35], v[140:143]
    s_add_u32 m0, s22, 49152
    v_exp_f32 v136, v136
    v_mfma_f32_16x16x32_bf16 v[144:147], a[96:99], a[32:35], v[208:211]
    buffer_load_dwordx4 v232, s[12:15], s24 offen offset:0 lds
    v_mfma_f32_16x16x32_bf16 v[144:147], a[100:103], a[36:39], v[144:147]
    v_exp_f32 v137, v137
    v_mfma_f32_16x16x32_bf16 v[144:147], a[104:107], a[40:43], v[144:147]
    v_cvt_pk_bf16_f32 v136, v136, v137
    v_mfma_f32_16x16x32_bf16 v[144:147], a[108:111], a[44:47], v[144:147]
    v_exp_f32 v138, v138
    v_mfma_f32_16x16x32_bf16 v[148:151], a[124:127], a[44:47], v[208:211]
    buffer_load_dwordx4 v233, s[12:15], s24 offen offset:1024 lds
    v_mfma_f32_16x16x32_bf16 v[148:151], a[120:123], a[40:43], v[148:151]
    v_exp_f32 v139, v139
    v_mfma_f32_16x16x32_bf16 v[148:151], a[116:119], a[36:39], v[148:151]
    v_cvt_pk_bf16_f32 v137, v138, v139
    v_mfma_f32_16x16x32_bf16 v[148:151], a[112:115], a[32:35], v[148:151]
    v_exp_f32 v140, v140
    v_smfmac_f32_16x16x64_bf16 a[196:199], a[208:211], v[152:159], v168
    buffer_load_dwordx4 v232, s[12:15], s24 offen offset:2048 lds
    v_mfma_f32_16x16x32_bf16 v[40:43], a[128:131], v[152:155], v[40:43]
    v_exp_f32 v141, v141
    v_mfma_f32_16x16x32_bf16 v[40:43], a[160:163], v[156:159], v[40:43]
    v_cvt_pk_bf16_f32 v138, v140, v141
    v_mfma_f32_16x16x32_bf16 v[44:47], a[132:135], v[152:155], v[44:47]
    v_exp_f32 v142, v142
    v_mfma_f32_16x16x32_bf16 v[44:47], a[164:167], v[156:159], v[44:47]
    buffer_load_dwordx4 v233, s[12:15], s24 offen offset:3072 lds
    v_mfma_f32_16x16x32_bf16 v[48:51], a[136:139], v[152:155], v[48:51]
    s_add_u32 s24, s24, 16384
    v_exp_f32 v143, v143
    v_mfma_f32_16x16x32_bf16 v[48:51], a[168:171], v[156:159], v[48:51]
    v_cvt_pk_bf16_f32 v139, v142, v143
    v_mfma_f32_16x16x32_bf16 v[52:55], a[140:143], v[152:155], v[52:55]
    v_exp_f32 v144, v144
    v_mfma_f32_16x16x32_bf16 v[52:55], a[172:175], v[156:159], v[52:55]
    v_mfma_f32_16x16x32_bf16 v[56:59], a[144:147], v[152:155], v[56:59]
    v_exp_f32 v145, v145
    v_mfma_f32_16x16x32_bf16 v[56:59], a[176:179], v[156:159], v[56:59]
    v_cvt_pk_bf16_f32 v140, v144, v145
    v_mfma_f32_16x16x32_bf16 v[60:63], a[148:151], v[152:155], v[60:63]
    v_exp_f32 v146, v146
    v_mfma_f32_16x16x32_bf16 v[60:63], a[180:183], v[156:159], v[60:63]
    v_mfma_f32_16x16x32_bf16 v[64:67], a[152:155], v[152:155], v[64:67]
    v_exp_f32 v147, v147
    v_mfma_f32_16x16x32_bf16 v[64:67], a[184:187], v[156:159], v[64:67]
    v_cvt_pk_bf16_f32 v141, v146, v147
    v_mfma_f32_16x16x32_bf16 v[68:71], a[156:159], v[152:155], v[68:71]
    v_exp_f32 v148, v148
    v_mfma_f32_16x16x32_bf16 v[68:71], a[188:191], v[156:159], v[68:71]
    v_mfma_f32_16x16x32_bf16 v[152:155], a[64:67], a[48:51], v[212:215]
    s_waitcnt vmcnt(8)
    s_barrier
    v_mfma_f32_16x16x32_bf16 v[152:155], a[68:71], a[52:55], v[152:155]
    v_exp_f32 v149, v149
    v_mfma_f32_16x16x32_bf16 v[152:155], a[72:75], a[56:59], v[152:155]
    ds_read_b128 a[64:67], v216 offset:16384
    v_cvt_pk_bf16_f32 v142, v148, v149
    v_mfma_f32_16x16x32_bf16 v[152:155], a[76:79], a[60:63], v[152:155]
    v_exp_f32 v150, v150
    v_mfma_f32_16x16x32_bf16 v[156:159], a[92:95], a[60:63], v[212:215]
    ds_read_b128 a[68:71], v217 offset:16384
    ds_read_b128 a[72:75], v218 offset:16384
    v_mfma_f32_16x16x32_bf16 v[156:159], a[88:91], a[56:59], v[156:159]
    v_exp_f32 v151, v151
    v_mfma_f32_16x16x32_bf16 v[156:159], a[84:87], a[52:55], v[156:159]
    ds_read_b128 a[76:79], v219 offset:16384
    v_cvt_pk_bf16_f32 v143, v150, v151
    v_mfma_f32_16x16x32_bf16 v[156:159], a[80:83], a[48:51], v[156:159]
    v_exp_f32 v152, v152
    v_mfma_f32_16x16x32_bf16 v[160:163], a[96:99], a[48:51], v[212:215]
    ds_read_b128 a[92:95], v219 offset:20480
    ds_read_b128 a[88:91], v218 offset:20480
    v_mfma_f32_16x16x32_bf16 v[160:163], a[100:103], a[52:55], v[160:163]
    v_exp_f32 v153, v153
    v_mfma_f32_16x16x32_bf16 v[160:163], a[104:107], a[56:59], v[160:163]
    ds_read_b128 a[84:87], v217 offset:20480
    v_cvt_pk_bf16_f32 v152, v152, v153
    v_mfma_f32_16x16x32_bf16 v[160:163], a[108:111], a[60:63], v[160:163]
    v_exp_f32 v154, v154
    v_mfma_f32_16x16x32_bf16 v[164:167], a[124:127], a[60:63], v[212:215]
    ds_read_b128 a[80:83], v216 offset:20480
    ds_read_b128 a[96:99], v216 offset:24576
    v_mfma_f32_16x16x32_bf16 v[164:167], a[120:123], a[56:59], v[164:167]
    v_exp_f32 v155, v155
    v_mfma_f32_16x16x32_bf16 v[164:167], a[116:119], a[52:55], v[164:167]
    ds_read_b128 a[100:103], v217 offset:24576
    v_cvt_pk_bf16_f32 v153, v154, v155
    v_mfma_f32_16x16x32_bf16 v[164:167], a[112:115], a[48:51], v[164:167]
    v_exp_f32 v156, v156
    v_smfmac_f32_16x16x64_bf16 a[200:203], a[208:211], v[136:143], v168
    ds_read_b128 a[104:107], v218 offset:24576
    ds_read_b128 a[108:111], v219 offset:24576
    v_mfma_f32_16x16x32_bf16 v[72:75], a[128:131], v[136:139], v[72:75]
    v_exp_f32 v157, v157
    v_mfma_f32_16x16x32_bf16 v[72:75], a[160:163], v[140:143], v[72:75]
    ds_read_b128 a[124:127], v219 offset:28672
    v_cvt_pk_bf16_f32 v154, v156, v157
    v_mfma_f32_16x16x32_bf16 v[76:79], a[132:135], v[136:139], v[76:79]
    v_exp_f32 v158, v158
    v_mfma_f32_16x16x32_bf16 v[76:79], a[164:167], v[140:143], v[76:79]
    ds_read_b128 a[120:123], v218 offset:28672
    ds_read_b128 a[116:119], v217 offset:28672
    v_mfma_f32_16x16x32_bf16 v[80:83], a[136:139], v[136:139], v[80:83]
    v_exp_f32 v159, v159
    v_mfma_f32_16x16x32_bf16 v[80:83], a[168:171], v[140:143], v[80:83]
    ds_read_b128 a[112:115], v216 offset:28672
    v_cvt_pk_bf16_f32 v155, v158, v159
    v_mfma_f32_16x16x32_bf16 v[84:87], a[140:143], v[136:139], v[84:87]
    v_exp_f32 v160, v160
    v_mfma_f32_16x16x32_bf16 v[84:87], a[172:175], v[140:143], v[84:87]
    v_mfma_f32_16x16x32_bf16 v[88:91], a[144:147], v[136:139], v[88:91]
    v_exp_f32 v161, v161
    v_mfma_f32_16x16x32_bf16 v[88:91], a[176:179], v[140:143], v[88:91]
    v_cvt_pk_bf16_f32 v156, v160, v161
    v_mfma_f32_16x16x32_bf16 v[92:95], a[148:151], v[136:139], v[92:95]
    v_exp_f32 v162, v162
    v_mfma_f32_16x16x32_bf16 v[92:95], a[180:183], v[140:143], v[92:95]
    v_mfma_f32_16x16x32_bf16 v[96:99], a[152:155], v[136:139], v[96:99]
    v_exp_f32 v163, v163
    v_mfma_f32_16x16x32_bf16 v[96:99], a[184:187], v[140:143], v[96:99]
    v_cvt_pk_bf16_f32 v157, v162, v163
    v_mfma_f32_16x16x32_bf16 v[100:103], a[156:159], v[136:139], v[100:103]
    v_exp_f32 v164, v164
    v_mfma_f32_16x16x32_bf16 v[100:103], a[188:191], v[140:143], v[100:103]
    s_waitcnt lgkmcnt(0)
    v_mfma_f32_16x16x32_bf16 v[136:139], a[64:67], a[0:3], v[200:203]
    v_mfma_f32_16x16x32_bf16 v[136:139], a[68:71], a[4:7], v[136:139]
    v_exp_f32 v165, v165
    v_mfma_f32_16x16x32_bf16 v[136:139], a[72:75], a[8:11], v[136:139]
    v_cvt_pk_bf16_f32 v158, v164, v165
    v_mfma_f32_16x16x32_bf16 v[136:139], a[76:79], a[12:15], v[136:139]
    s_add_u32 m0, s21, 49152
    v_exp_f32 v166, v166
    v_mfma_f32_16x16x32_bf16 v[140:143], a[92:95], a[12:15], v[200:203]
    buffer_load_dwordx4 v228, s[8:11], s23 offen offset:0 lds
    v_mfma_f32_16x16x32_bf16 v[140:143], a[88:91], a[8:11], v[140:143]
    v_exp_f32 v167, v167
    v_mfma_f32_16x16x32_bf16 v[140:143], a[84:87], a[4:7], v[140:143]
    v_cvt_pk_bf16_f32 v159, v166, v167
    v_mfma_f32_16x16x32_bf16 v[140:143], a[80:83], a[0:3], v[140:143]
    v_exp_f32 v136, v136
    v_mfma_f32_16x16x32_bf16 v[144:147], a[96:99], a[0:3], v[200:203]
    buffer_load_dwordx4 v229, s[8:11], s23 offen offset:1024 lds
    v_mfma_f32_16x16x32_bf16 v[144:147], a[100:103], a[4:7], v[144:147]
    v_exp_f32 v137, v137
    v_mfma_f32_16x16x32_bf16 v[144:147], a[104:107], a[8:11], v[144:147]
    v_cvt_pk_bf16_f32 v136, v136, v137
    v_mfma_f32_16x16x32_bf16 v[144:147], a[108:111], a[12:15], v[144:147]
    v_exp_f32 v138, v138
    v_mfma_f32_16x16x32_bf16 v[148:151], a[124:127], a[12:15], v[200:203]
    buffer_load_dwordx4 v230, s[8:11], s23 offen offset:2048 lds
    v_mfma_f32_16x16x32_bf16 v[148:151], a[120:123], a[8:11], v[148:151]
    v_exp_f32 v139, v139
    v_mfma_f32_16x16x32_bf16 v[148:151], a[116:119], a[4:7], v[148:151]
    v_cvt_pk_bf16_f32 v137, v138, v139
    v_mfma_f32_16x16x32_bf16 v[148:151], a[112:115], a[0:3], v[148:151]
    v_exp_f32 v140, v140
    v_smfmac_f32_16x16x64_bf16 a[204:207], a[208:211], v[152:159], v168
    buffer_load_dwordx4 v231, s[8:11], s23 offen offset:3072 lds
    v_mfma_f32_16x16x32_bf16 v[104:107], a[128:131], v[152:155], v[104:107]
    s_add_u32 s23, s23, 16384
    v_exp_f32 v141, v141
    v_mfma_f32_16x16x32_bf16 v[104:107], a[160:163], v[156:159], v[104:107]
    ds_read_b64_tr_b16 a[128:129], v220 offset:32768
    v_cvt_pk_bf16_f32 v138, v140, v141
    v_mfma_f32_16x16x32_bf16 v[108:111], a[132:135], v[152:155], v[108:111]
    v_exp_f32 v142, v142
    v_mfma_f32_16x16x32_bf16 v[108:111], a[164:167], v[156:159], v[108:111]
    ds_read_b64_tr_b16 a[130:131], v220 offset:36864
    ds_read_b64_tr_b16 a[160:161], v220 offset:40960
    v_mfma_f32_16x16x32_bf16 v[112:115], a[136:139], v[152:155], v[112:115]
    v_exp_f32 v143, v143
    v_mfma_f32_16x16x32_bf16 v[112:115], a[168:171], v[156:159], v[112:115]
    ds_read_b64_tr_b16 a[162:163], v220 offset:45056
    v_cvt_pk_bf16_f32 v139, v142, v143
    v_mfma_f32_16x16x32_bf16 v[116:119], a[140:143], v[152:155], v[116:119]
    v_exp_f32 v144, v144
    v_mfma_f32_16x16x32_bf16 v[116:119], a[172:175], v[156:159], v[116:119]
    ds_read_b64_tr_b16 a[132:133], v221 offset:32768
    ds_read_b64_tr_b16 a[134:135], v221 offset:36864
    v_mfma_f32_16x16x32_bf16 v[120:123], a[144:147], v[152:155], v[120:123]
    v_exp_f32 v145, v145
    v_mfma_f32_16x16x32_bf16 v[120:123], a[176:179], v[156:159], v[120:123]
    ds_read_b64_tr_b16 a[164:165], v221 offset:40960
    v_cvt_pk_bf16_f32 v140, v144, v145
    v_mfma_f32_16x16x32_bf16 v[124:127], a[148:151], v[152:155], v[124:127]
    v_exp_f32 v146, v146
    v_mfma_f32_16x16x32_bf16 v[124:127], a[180:183], v[156:159], v[124:127]
    ds_read_b64_tr_b16 a[166:167], v221 offset:45056
    ds_read_b64_tr_b16 a[136:137], v222 offset:32768
    v_mfma_f32_16x16x32_bf16 v[128:131], a[152:155], v[152:155], v[128:131]
    v_exp_f32 v147, v147
    v_mfma_f32_16x16x32_bf16 v[128:131], a[184:187], v[156:159], v[128:131]
    ds_read_b64_tr_b16 a[138:139], v222 offset:36864
    v_cvt_pk_bf16_f32 v141, v146, v147
    v_mfma_f32_16x16x32_bf16 v[132:135], a[156:159], v[152:155], v[132:135]
    v_exp_f32 v148, v148
    v_mfma_f32_16x16x32_bf16 v[132:135], a[188:191], v[156:159], v[132:135]
    ds_read_b64_tr_b16 a[168:169], v222 offset:40960
    ds_read_b64_tr_b16 a[170:171], v222 offset:45056
    v_mfma_f32_16x16x32_bf16 v[152:155], a[64:67], a[16:19], v[204:207]
    ds_read_b64_tr_b16 a[140:141], v223 offset:32768
    v_mfma_f32_16x16x32_bf16 v[152:155], a[68:71], a[20:23], v[152:155]
    v_exp_f32 v149, v149
    v_mfma_f32_16x16x32_bf16 v[152:155], a[72:75], a[24:27], v[152:155]
    ds_read_b64_tr_b16 a[142:143], v223 offset:36864
    v_cvt_pk_bf16_f32 v142, v148, v149
    v_mfma_f32_16x16x32_bf16 v[152:155], a[76:79], a[28:31], v[152:155]
    v_exp_f32 v150, v150
    v_mfma_f32_16x16x32_bf16 v[156:159], a[92:95], a[28:31], v[204:207]
    ds_read_b64_tr_b16 a[172:173], v223 offset:40960
    ds_read_b64_tr_b16 a[174:175], v223 offset:45056
    v_mfma_f32_16x16x32_bf16 v[156:159], a[88:91], a[24:27], v[156:159]
    v_exp_f32 v151, v151
    v_mfma_f32_16x16x32_bf16 v[156:159], a[84:87], a[20:23], v[156:159]
    ds_read_b64_tr_b16 a[144:145], v224 offset:32768
    v_cvt_pk_bf16_f32 v143, v150, v151
    v_mfma_f32_16x16x32_bf16 v[156:159], a[80:83], a[16:19], v[156:159]
    v_exp_f32 v152, v152
    v_mfma_f32_16x16x32_bf16 v[160:163], a[96:99], a[16:19], v[204:207]
    ds_read_b64_tr_b16 a[146:147], v224 offset:36864
    ds_read_b64_tr_b16 a[176:177], v224 offset:40960
    v_mfma_f32_16x16x32_bf16 v[160:163], a[100:103], a[20:23], v[160:163]
    v_exp_f32 v153, v153
    v_mfma_f32_16x16x32_bf16 v[160:163], a[104:107], a[24:27], v[160:163]
    ds_read_b64_tr_b16 a[178:179], v224 offset:45056
    v_cvt_pk_bf16_f32 v152, v152, v153
    v_mfma_f32_16x16x32_bf16 v[160:163], a[108:111], a[28:31], v[160:163]
    v_exp_f32 v154, v154
    v_mfma_f32_16x16x32_bf16 v[164:167], a[124:127], a[28:31], v[204:207]
    ds_read_b64_tr_b16 a[148:149], v225 offset:32768
    ds_read_b64_tr_b16 a[150:151], v225 offset:36864
    v_mfma_f32_16x16x32_bf16 v[164:167], a[120:123], a[24:27], v[164:167]
    v_exp_f32 v155, v155
    v_mfma_f32_16x16x32_bf16 v[164:167], a[116:119], a[20:23], v[164:167]
    ds_read_b64_tr_b16 a[180:181], v225 offset:40960
    v_cvt_pk_bf16_f32 v153, v154, v155
    v_mfma_f32_16x16x32_bf16 v[164:167], a[112:115], a[16:19], v[164:167]
    v_exp_f32 v156, v156
    v_smfmac_f32_16x16x64_bf16 a[192:195], a[208:211], v[136:143], v168
    s_waitcnt lgkmcnt(2)
    ds_read_b64_tr_b16 a[182:183], v225 offset:45056
    ds_read_b64_tr_b16 a[152:153], v226 offset:32768
    v_mfma_f32_16x16x32_bf16 v[8:11], a[128:131], v[136:139], v[8:11]
    v_exp_f32 v157, v157
    v_mfma_f32_16x16x32_bf16 v[8:11], a[160:163], v[140:143], v[8:11]
    ds_read_b64_tr_b16 a[154:155], v226 offset:36864
    v_cvt_pk_bf16_f32 v154, v156, v157
    v_mfma_f32_16x16x32_bf16 v[12:15], a[132:135], v[136:139], v[12:15]
    v_exp_f32 v158, v158
    v_mfma_f32_16x16x32_bf16 v[12:15], a[164:167], v[140:143], v[12:15]
    ds_read_b64_tr_b16 a[184:185], v226 offset:40960
    ds_read_b64_tr_b16 a[186:187], v226 offset:45056
    v_mfma_f32_16x16x32_bf16 v[16:19], a[136:139], v[136:139], v[16:19]
    v_exp_f32 v159, v159
    v_mfma_f32_16x16x32_bf16 v[16:19], a[168:171], v[140:143], v[16:19]
    ds_read_b64_tr_b16 a[156:157], v227 offset:32768
    v_cvt_pk_bf16_f32 v155, v158, v159
    v_mfma_f32_16x16x32_bf16 v[20:23], a[140:143], v[136:139], v[20:23]
    v_exp_f32 v160, v160
    v_mfma_f32_16x16x32_bf16 v[20:23], a[172:175], v[140:143], v[20:23]
    ds_read_b64_tr_b16 a[158:159], v227 offset:36864
    ds_read_b64_tr_b16 a[188:189], v227 offset:40960
    v_mfma_f32_16x16x32_bf16 v[24:27], a[144:147], v[136:139], v[24:27]
    v_exp_f32 v161, v161
    v_mfma_f32_16x16x32_bf16 v[24:27], a[176:179], v[140:143], v[24:27]
    s_waitcnt lgkmcnt(2)
    ds_read_b64_tr_b16 a[190:191], v227 offset:45056
    v_cvt_pk_bf16_f32 v156, v160, v161
    v_mfma_f32_16x16x32_bf16 v[28:31], a[148:151], v[136:139], v[28:31]
    v_exp_f32 v162, v162
    v_mfma_f32_16x16x32_bf16 v[28:31], a[180:183], v[140:143], v[28:31]
    v_mfma_f32_16x16x32_bf16 v[32:35], a[152:155], v[136:139], v[32:35]
    v_exp_f32 v163, v163
    v_mfma_f32_16x16x32_bf16 v[32:35], a[184:187], v[140:143], v[32:35]
    s_waitcnt lgkmcnt(1)
    v_cvt_pk_bf16_f32 v157, v162, v163
    v_mfma_f32_16x16x32_bf16 v[36:39], a[156:159], v[136:139], v[36:39]
    s_waitcnt lgkmcnt(0)
    v_exp_f32 v164, v164
    v_mfma_f32_16x16x32_bf16 v[36:39], a[188:191], v[140:143], v[36:39]
    v_mfma_f32_16x16x32_bf16 v[136:139], a[64:67], a[32:35], v[208:211]
    v_mfma_f32_16x16x32_bf16 v[136:139], a[68:71], a[36:39], v[136:139]
    v_exp_f32 v165, v165
    v_mfma_f32_16x16x32_bf16 v[136:139], a[72:75], a[40:43], v[136:139]
    v_cvt_pk_bf16_f32 v158, v164, v165
    v_mfma_f32_16x16x32_bf16 v[136:139], a[76:79], a[44:47], v[136:139]
    v_exp_f32 v166, v166
    v_mfma_f32_16x16x32_bf16 v[140:143], a[92:95], a[44:47], v[208:211]
    s_nop 0
    v_mfma_f32_16x16x32_bf16 v[140:143], a[88:91], a[40:43], v[140:143]
    v_exp_f32 v167, v167
    v_mfma_f32_16x16x32_bf16 v[140:143], a[84:87], a[36:39], v[140:143]
    v_cvt_pk_bf16_f32 v159, v166, v167
    v_mfma_f32_16x16x32_bf16 v[140:143], a[80:83], a[32:35], v[140:143]
    s_add_u32 m0, s22, 0
    v_exp_f32 v136, v136
    v_mfma_f32_16x16x32_bf16 v[144:147], a[96:99], a[32:35], v[208:211]
    buffer_load_dwordx4 v232, s[12:15], s24 offen offset:0 lds
    v_mfma_f32_16x16x32_bf16 v[144:147], a[100:103], a[36:39], v[144:147]
    v_exp_f32 v137, v137
    v_mfma_f32_16x16x32_bf16 v[144:147], a[104:107], a[40:43], v[144:147]
    v_cvt_pk_bf16_f32 v136, v136, v137
    v_mfma_f32_16x16x32_bf16 v[144:147], a[108:111], a[44:47], v[144:147]
    v_exp_f32 v138, v138
    v_mfma_f32_16x16x32_bf16 v[148:151], a[124:127], a[44:47], v[208:211]
    buffer_load_dwordx4 v233, s[12:15], s24 offen offset:1024 lds
    v_mfma_f32_16x16x32_bf16 v[148:151], a[120:123], a[40:43], v[148:151]
    v_exp_f32 v139, v139
    v_mfma_f32_16x16x32_bf16 v[148:151], a[116:119], a[36:39], v[148:151]
    v_cvt_pk_bf16_f32 v137, v138, v139
    v_mfma_f32_16x16x32_bf16 v[148:151], a[112:115], a[32:35], v[148:151]
    v_exp_f32 v140, v140
    v_smfmac_f32_16x16x64_bf16 a[196:199], a[208:211], v[152:159], v168
    buffer_load_dwordx4 v232, s[12:15], s24 offen offset:2048 lds
    v_mfma_f32_16x16x32_bf16 v[40:43], a[128:131], v[152:155], v[40:43]
    v_exp_f32 v141, v141
    v_mfma_f32_16x16x32_bf16 v[40:43], a[160:163], v[156:159], v[40:43]
    v_cvt_pk_bf16_f32 v138, v140, v141
    v_mfma_f32_16x16x32_bf16 v[44:47], a[132:135], v[152:155], v[44:47]
    v_exp_f32 v142, v142
    v_mfma_f32_16x16x32_bf16 v[44:47], a[164:167], v[156:159], v[44:47]
    buffer_load_dwordx4 v233, s[12:15], s24 offen offset:3072 lds
    v_mfma_f32_16x16x32_bf16 v[48:51], a[136:139], v[152:155], v[48:51]
    s_add_u32 s24, s24, 16384
    v_exp_f32 v143, v143
    v_mfma_f32_16x16x32_bf16 v[48:51], a[168:171], v[156:159], v[48:51]
    v_cvt_pk_bf16_f32 v139, v142, v143
    v_mfma_f32_16x16x32_bf16 v[52:55], a[140:143], v[152:155], v[52:55]
    v_exp_f32 v144, v144
    v_mfma_f32_16x16x32_bf16 v[52:55], a[172:175], v[156:159], v[52:55]
    v_mfma_f32_16x16x32_bf16 v[56:59], a[144:147], v[152:155], v[56:59]
    v_exp_f32 v145, v145
    v_mfma_f32_16x16x32_bf16 v[56:59], a[176:179], v[156:159], v[56:59]
    v_cvt_pk_bf16_f32 v140, v144, v145
    v_mfma_f32_16x16x32_bf16 v[60:63], a[148:151], v[152:155], v[60:63]
    v_exp_f32 v146, v146
    v_mfma_f32_16x16x32_bf16 v[60:63], a[180:183], v[156:159], v[60:63]
    v_mfma_f32_16x16x32_bf16 v[64:67], a[152:155], v[152:155], v[64:67]
    s_add_u32 s25, s25, 1
    v_exp_f32 v147, v147
    v_mfma_f32_16x16x32_bf16 v[64:67], a[184:187], v[156:159], v[64:67]
    v_cvt_pk_bf16_f32 v141, v146, v147
    v_mfma_f32_16x16x32_bf16 v[68:71], a[156:159], v[152:155], v[68:71]
    s_cmp_lt_u32 s25, 3
    v_exp_f32 v148, v148
    v_mfma_f32_16x16x32_bf16 v[68:71], a[188:191], v[156:159], v[68:71]
    s_cbranch_scc1 L_loop
    v_mfma_f32_16x16x32_bf16 v[152:155], a[64:67], a[48:51], v[212:215]
    s_waitcnt vmcnt(8)
    s_barrier
    v_mfma_f32_16x16x32_bf16 v[152:155], a[68:71], a[52:55], v[152:155]
    v_exp_f32 v149, v149
    v_mfma_f32_16x16x32_bf16 v[152:155], a[72:75], a[56:59], v[152:155]
    ds_read_b128 a[64:67], v216 offset:32768
    v_cvt_pk_bf16_f32 v142, v148, v149
    v_mfma_f32_16x16x32_bf16 v[152:155], a[76:79], a[60:63], v[152:155]
    v_exp_f32 v150, v150
    v_mfma_f32_16x16x32_bf16 v[156:159], a[92:95], a[60:63], v[212:215]
    ds_read_b128 a[68:71], v217 offset:32768
    ds_read_b128 a[72:75], v218 offset:32768
    v_mfma_f32_16x16x32_bf16 v[156:159], a[88:91], a[56:59], v[156:159]
    v_exp_f32 v151, v151
    v_mfma_f32_16x16x32_bf16 v[156:159], a[84:87], a[52:55], v[156:159]
    ds_read_b128 a[76:79], v219 offset:32768
    v_cvt_pk_bf16_f32 v143, v150, v151
    v_mfma_f32_16x16x32_bf16 v[156:159], a[80:83], a[48:51], v[156:159]
    v_exp_f32 v152, v152
    v_mfma_f32_16x16x32_bf16 v[160:163], a[96:99], a[48:51], v[212:215]
    ds_read_b128 a[92:95], v219 offset:36864
    ds_read_b128 a[88:91], v218 offset:36864
    v_mfma_f32_16x16x32_bf16 v[160:163], a[100:103], a[52:55], v[160:163]
    v_exp_f32 v153, v153
    v_mfma_f32_16x16x32_bf16 v[160:163], a[104:107], a[56:59], v[160:163]
    ds_read_b128 a[84:87], v217 offset:36864
    v_cvt_pk_bf16_f32 v152, v152, v153
    v_mfma_f32_16x16x32_bf16 v[160:163], a[108:111], a[60:63], v[160:163]
    v_exp_f32 v154, v154
    v_mfma_f32_16x16x32_bf16 v[164:167], a[124:127], a[60:63], v[212:215]
    ds_read_b128 a[80:83], v216 offset:36864
    ds_read_b128 a[96:99], v216 offset:40960
    v_mfma_f32_16x16x32_bf16 v[164:167], a[120:123], a[56:59], v[164:167]
    v_exp_f32 v155, v155
    v_mfma_f32_16x16x32_bf16 v[164:167], a[116:119], a[52:55], v[164:167]
    ds_read_b128 a[100:103], v217 offset:40960
    v_cvt_pk_bf16_f32 v153, v154, v155
    v_mfma_f32_16x16x32_bf16 v[164:167], a[112:115], a[48:51], v[164:167]
    v_exp_f32 v156, v156
    v_smfmac_f32_16x16x64_bf16 a[200:203], a[208:211], v[136:143], v168
    ds_read_b128 a[104:107], v218 offset:40960
    ds_read_b128 a[108:111], v219 offset:40960
    v_mfma_f32_16x16x32_bf16 v[72:75], a[128:131], v[136:139], v[72:75]
    v_exp_f32 v157, v157
    v_mfma_f32_16x16x32_bf16 v[72:75], a[160:163], v[140:143], v[72:75]
    ds_read_b128 a[124:127], v219 offset:45056
    v_cvt_pk_bf16_f32 v154, v156, v157
    v_mfma_f32_16x16x32_bf16 v[76:79], a[132:135], v[136:139], v[76:79]
    v_exp_f32 v158, v158
    v_mfma_f32_16x16x32_bf16 v[76:79], a[164:167], v[140:143], v[76:79]
    ds_read_b128 a[120:123], v218 offset:45056
    ds_read_b128 a[116:119], v217 offset:45056
    v_mfma_f32_16x16x32_bf16 v[80:83], a[136:139], v[136:139], v[80:83]
    v_exp_f32 v159, v159
    v_mfma_f32_16x16x32_bf16 v[80:83], a[168:171], v[140:143], v[80:83]
    ds_read_b128 a[112:115], v216 offset:45056
    v_cvt_pk_bf16_f32 v155, v158, v159
    v_mfma_f32_16x16x32_bf16 v[84:87], a[140:143], v[136:139], v[84:87]
    v_exp_f32 v160, v160
    v_mfma_f32_16x16x32_bf16 v[84:87], a[172:175], v[140:143], v[84:87]
    v_mfma_f32_16x16x32_bf16 v[88:91], a[144:147], v[136:139], v[88:91]
    v_exp_f32 v161, v161
    v_mfma_f32_16x16x32_bf16 v[88:91], a[176:179], v[140:143], v[88:91]
    v_cvt_pk_bf16_f32 v156, v160, v161
    v_mfma_f32_16x16x32_bf16 v[92:95], a[148:151], v[136:139], v[92:95]
    v_exp_f32 v162, v162
    v_mfma_f32_16x16x32_bf16 v[92:95], a[180:183], v[140:143], v[92:95]
    v_mfma_f32_16x16x32_bf16 v[96:99], a[152:155], v[136:139], v[96:99]
    v_exp_f32 v163, v163
    v_mfma_f32_16x16x32_bf16 v[96:99], a[184:187], v[140:143], v[96:99]
    v_cvt_pk_bf16_f32 v157, v162, v163
    v_mfma_f32_16x16x32_bf16 v[100:103], a[156:159], v[136:139], v[100:103]
    v_exp_f32 v164, v164
    v_mfma_f32_16x16x32_bf16 v[100:103], a[188:191], v[140:143], v[100:103]
    s_waitcnt lgkmcnt(0)
    v_mfma_f32_16x16x32_bf16 v[136:139], a[64:67], a[0:3], v[200:203]
    v_mfma_f32_16x16x32_bf16 v[136:139], a[68:71], a[4:7], v[136:139]
    v_exp_f32 v165, v165
    v_mfma_f32_16x16x32_bf16 v[136:139], a[72:75], a[8:11], v[136:139]
    v_cvt_pk_bf16_f32 v158, v164, v165
    v_mfma_f32_16x16x32_bf16 v[136:139], a[76:79], a[12:15], v[136:139]
    v_exp_f32 v166, v166
    v_mfma_f32_16x16x32_bf16 v[140:143], a[92:95], a[12:15], v[200:203]
    s_nop 0
    v_mfma_f32_16x16x32_bf16 v[140:143], a[88:91], a[8:11], v[140:143]
    v_exp_f32 v167, v167
    v_mfma_f32_16x16x32_bf16 v[140:143], a[84:87], a[4:7], v[140:143]
    v_cvt_pk_bf16_f32 v159, v166, v167
    v_mfma_f32_16x16x32_bf16 v[140:143], a[80:83], a[0:3], v[140:143]
    v_exp_f32 v136, v136
    v_mfma_f32_16x16x32_bf16 v[144:147], a[96:99], a[0:3], v[200:203]
    v_mfma_f32_16x16x32_bf16 v[144:147], a[100:103], a[4:7], v[144:147]
    v_exp_f32 v137, v137
    v_mfma_f32_16x16x32_bf16 v[144:147], a[104:107], a[8:11], v[144:147]
    v_cvt_pk_bf16_f32 v136, v136, v137
    v_mfma_f32_16x16x32_bf16 v[144:147], a[108:111], a[12:15], v[144:147]
    v_exp_f32 v138, v138
    v_mfma_f32_16x16x32_bf16 v[148:151], a[124:127], a[12:15], v[200:203]
    v_mfma_f32_16x16x32_bf16 v[148:151], a[120:123], a[8:11], v[148:151]
    v_exp_f32 v139, v139
    v_mfma_f32_16x16x32_bf16 v[148:151], a[116:119], a[4:7], v[148:151]
    v_cvt_pk_bf16_f32 v137, v138, v139
    v_mfma_f32_16x16x32_bf16 v[148:151], a[112:115], a[0:3], v[148:151]
    v_exp_f32 v140, v140
    v_smfmac_f32_16x16x64_bf16 a[204:207], a[208:211], v[152:159], v168
    v_mfma_f32_16x16x32_bf16 v[104:107], a[128:131], v[152:155], v[104:107]
    v_exp_f32 v141, v141
    v_mfma_f32_16x16x32_bf16 v[104:107], a[160:163], v[156:159], v[104:107]
    ds_read_b64_tr_b16 a[128:129], v220 offset:49152
    v_cvt_pk_bf16_f32 v138, v140, v141
    v_mfma_f32_16x16x32_bf16 v[108:111], a[132:135], v[152:155], v[108:111]
    v_exp_f32 v142, v142
    v_mfma_f32_16x16x32_bf16 v[108:111], a[164:167], v[156:159], v[108:111]
    ds_read_b64_tr_b16 a[130:131], v220 offset:53248
    ds_read_b64_tr_b16 a[160:161], v220 offset:57344
    v_mfma_f32_16x16x32_bf16 v[112:115], a[136:139], v[152:155], v[112:115]
    v_exp_f32 v143, v143
    v_mfma_f32_16x16x32_bf16 v[112:115], a[168:171], v[156:159], v[112:115]
    ds_read_b64_tr_b16 a[162:163], v220 offset:61440
    v_cvt_pk_bf16_f32 v139, v142, v143
    v_mfma_f32_16x16x32_bf16 v[116:119], a[140:143], v[152:155], v[116:119]
    v_exp_f32 v144, v144
    v_mfma_f32_16x16x32_bf16 v[116:119], a[172:175], v[156:159], v[116:119]
    ds_read_b64_tr_b16 a[132:133], v221 offset:49152
    ds_read_b64_tr_b16 a[134:135], v221 offset:53248
    v_mfma_f32_16x16x32_bf16 v[120:123], a[144:147], v[152:155], v[120:123]
    v_exp_f32 v145, v145
    v_mfma_f32_16x16x32_bf16 v[120:123], a[176:179], v[156:159], v[120:123]
    ds_read_b64_tr_b16 a[164:165], v221 offset:57344
    v_cvt_pk_bf16_f32 v140, v144, v145
    v_mfma_f32_16x16x32_bf16 v[124:127], a[148:151], v[152:155], v[124:127]
    v_exp_f32 v146, v146
    v_mfma_f32_16x16x32_bf16 v[124:127], a[180:183], v[156:159], v[124:127]
    ds_read_b64_tr_b16 a[166:167], v221 offset:61440
    ds_read_b64_tr_b16 a[136:137], v222 offset:49152
    v_mfma_f32_16x16x32_bf16 v[128:131], a[152:155], v[152:155], v[128:131]
    v_exp_f32 v147, v147
    v_mfma_f32_16x16x32_bf16 v[128:131], a[184:187], v[156:159], v[128:131]
    ds_read_b64_tr_b16 a[138:139], v222 offset:53248
    v_cvt_pk_bf16_f32 v141, v146, v147
    v_mfma_f32_16x16x32_bf16 v[132:135], a[156:159], v[152:155], v[132:135]
    v_exp_f32 v148, v148
    v_mfma_f32_16x16x32_bf16 v[132:135], a[188:191], v[156:159], v[132:135]
    ds_read_b64_tr_b16 a[168:169], v222 offset:57344
    ds_read_b64_tr_b16 a[170:171], v222 offset:61440
    v_mfma_f32_16x16x32_bf16 v[152:155], a[64:67], a[16:19], v[204:207]
    ds_read_b64_tr_b16 a[140:141], v223 offset:49152
    v_mfma_f32_16x16x32_bf16 v[152:155], a[68:71], a[20:23], v[152:155]
    v_exp_f32 v149, v149
    v_mfma_f32_16x16x32_bf16 v[152:155], a[72:75], a[24:27], v[152:155]
    ds_read_b64_tr_b16 a[142:143], v223 offset:53248
    v_cvt_pk_bf16_f32 v142, v148, v149
    v_mfma_f32_16x16x32_bf16 v[152:155], a[76:79], a[28:31], v[152:155]
    v_exp_f32 v150, v150
    v_mfma_f32_16x16x32_bf16 v[156:159], a[92:95], a[28:31], v[204:207]
    ds_read_b64_tr_b16 a[172:173], v223 offset:57344
    ds_read_b64_tr_b16 a[174:175], v223 offset:61440
    v_mfma_f32_16x16x32_bf16 v[156:159], a[88:91], a[24:27], v[156:159]
    v_exp_f32 v151, v151
    v_mfma_f32_16x16x32_bf16 v[156:159], a[84:87], a[20:23], v[156:159]
    ds_read_b64_tr_b16 a[144:145], v224 offset:49152
    v_cvt_pk_bf16_f32 v143, v150, v151
    v_mfma_f32_16x16x32_bf16 v[156:159], a[80:83], a[16:19], v[156:159]
    v_exp_f32 v152, v152
    v_mfma_f32_16x16x32_bf16 v[160:163], a[96:99], a[16:19], v[204:207]
    ds_read_b64_tr_b16 a[146:147], v224 offset:53248
    ds_read_b64_tr_b16 a[176:177], v224 offset:57344
    v_mfma_f32_16x16x32_bf16 v[160:163], a[100:103], a[20:23], v[160:163]
    v_exp_f32 v153, v153
    v_mfma_f32_16x16x32_bf16 v[160:163], a[104:107], a[24:27], v[160:163]
    ds_read_b64_tr_b16 a[178:179], v224 offset:61440
    v_cvt_pk_bf16_f32 v152, v152, v153
    v_mfma_f32_16x16x32_bf16 v[160:163], a[108:111], a[28:31], v[160:163]
    v_exp_f32 v154, v154
    v_mfma_f32_16x16x32_bf16 v[164:167], a[124:127], a[28:31], v[204:207]
    ds_read_b64_tr_b16 a[148:149], v225 offset:49152
    ds_read_b64_tr_b16 a[150:151], v225 offset:53248
    v_mfma_f32_16x16x32_bf16 v[164:167], a[120:123], a[24:27], v[164:167]
    v_exp_f32 v155, v155
    v_mfma_f32_16x16x32_bf16 v[164:167], a[116:119], a[20:23], v[164:167]
    ds_read_b64_tr_b16 a[180:181], v225 offset:57344
    v_cvt_pk_bf16_f32 v153, v154, v155
    v_mfma_f32_16x16x32_bf16 v[164:167], a[112:115], a[16:19], v[164:167]
    v_exp_f32 v156, v156
    v_smfmac_f32_16x16x64_bf16 a[192:195], a[208:211], v[136:143], v168
    s_waitcnt lgkmcnt(2)
    ds_read_b64_tr_b16 a[182:183], v225 offset:61440
    ds_read_b64_tr_b16 a[152:153], v226 offset:49152
    v_mfma_f32_16x16x32_bf16 v[8:11], a[128:131], v[136:139], v[8:11]
    v_exp_f32 v157, v157
    v_mfma_f32_16x16x32_bf16 v[8:11], a[160:163], v[140:143], v[8:11]
    ds_read_b64_tr_b16 a[154:155], v226 offset:53248
    v_cvt_pk_bf16_f32 v154, v156, v157
    v_mfma_f32_16x16x32_bf16 v[12:15], a[132:135], v[136:139], v[12:15]
    v_exp_f32 v158, v158
    v_mfma_f32_16x16x32_bf16 v[12:15], a[164:167], v[140:143], v[12:15]
    ds_read_b64_tr_b16 a[184:185], v226 offset:57344
    ds_read_b64_tr_b16 a[186:187], v226 offset:61440
    v_mfma_f32_16x16x32_bf16 v[16:19], a[136:139], v[136:139], v[16:19]
    v_exp_f32 v159, v159
    v_mfma_f32_16x16x32_bf16 v[16:19], a[168:171], v[140:143], v[16:19]
    ds_read_b64_tr_b16 a[156:157], v227 offset:49152
    v_cvt_pk_bf16_f32 v155, v158, v159
    v_mfma_f32_16x16x32_bf16 v[20:23], a[140:143], v[136:139], v[20:23]
    v_exp_f32 v160, v160
    v_mfma_f32_16x16x32_bf16 v[20:23], a[172:175], v[140:143], v[20:23]
    ds_read_b64_tr_b16 a[158:159], v227 offset:53248
    ds_read_b64_tr_b16 a[188:189], v227 offset:57344
    v_mfma_f32_16x16x32_bf16 v[24:27], a[144:147], v[136:139], v[24:27]
    v_exp_f32 v161, v161
    v_mfma_f32_16x16x32_bf16 v[24:27], a[176:179], v[140:143], v[24:27]
    s_waitcnt lgkmcnt(2)
    ds_read_b64_tr_b16 a[190:191], v227 offset:61440
    v_cvt_pk_bf16_f32 v156, v160, v161
    v_mfma_f32_16x16x32_bf16 v[28:31], a[148:151], v[136:139], v[28:31]
    v_exp_f32 v162, v162
    v_mfma_f32_16x16x32_bf16 v[28:31], a[180:183], v[140:143], v[28:31]
    v_mfma_f32_16x16x32_bf16 v[32:35], a[152:155], v[136:139], v[32:35]
    v_exp_f32 v163, v163
    v_mfma_f32_16x16x32_bf16 v[32:35], a[184:187], v[140:143], v[32:35]
    s_waitcnt lgkmcnt(1)
    v_cvt_pk_bf16_f32 v157, v162, v163
    v_mfma_f32_16x16x32_bf16 v[36:39], a[156:159], v[136:139], v[36:39]
    s_waitcnt lgkmcnt(0)
    v_exp_f32 v164, v164
    v_mfma_f32_16x16x32_bf16 v[36:39], a[188:191], v[140:143], v[36:39]
    v_mfma_f32_16x16x32_bf16 v[136:139], a[64:67], a[32:35], v[208:211]
    v_mfma_f32_16x16x32_bf16 v[136:139], a[68:71], a[36:39], v[136:139]
    v_exp_f32 v165, v165
    v_mfma_f32_16x16x32_bf16 v[136:139], a[72:75], a[40:43], v[136:139]
    v_cvt_pk_bf16_f32 v158, v164, v165
    v_mfma_f32_16x16x32_bf16 v[136:139], a[76:79], a[44:47], v[136:139]
    v_exp_f32 v166, v166
    v_mfma_f32_16x16x32_bf16 v[140:143], a[92:95], a[44:47], v[208:211]
    s_nop 0
    v_mfma_f32_16x16x32_bf16 v[140:143], a[88:91], a[40:43], v[140:143]
    v_exp_f32 v167, v167
    v_mfma_f32_16x16x32_bf16 v[140:143], a[84:87], a[36:39], v[140:143]
    v_cvt_pk_bf16_f32 v159, v166, v167
    v_mfma_f32_16x16x32_bf16 v[140:143], a[80:83], a[32:35], v[140:143]
    v_exp_f32 v136, v136
    v_mfma_f32_16x16x32_bf16 v[144:147], a[96:99], a[32:35], v[208:211]
    v_mfma_f32_16x16x32_bf16 v[144:147], a[100:103], a[36:39], v[144:147]
    v_exp_f32 v137, v137
    v_mfma_f32_16x16x32_bf16 v[144:147], a[104:107], a[40:43], v[144:147]
    v_cvt_pk_bf16_f32 v136, v136, v137
    v_mfma_f32_16x16x32_bf16 v[144:147], a[108:111], a[44:47], v[144:147]
    v_exp_f32 v138, v138
    v_mfma_f32_16x16x32_bf16 v[148:151], a[124:127], a[44:47], v[208:211]
    v_mfma_f32_16x16x32_bf16 v[148:151], a[120:123], a[40:43], v[148:151]
    v_exp_f32 v139, v139
    v_mfma_f32_16x16x32_bf16 v[148:151], a[116:119], a[36:39], v[148:151]
    v_cvt_pk_bf16_f32 v137, v138, v139
    v_mfma_f32_16x16x32_bf16 v[148:151], a[112:115], a[32:35], v[148:151]
    v_exp_f32 v140, v140
    v_smfmac_f32_16x16x64_bf16 a[196:199], a[208:211], v[152:159], v168
    v_mfma_f32_16x16x32_bf16 v[40:43], a[128:131], v[152:155], v[40:43]
    v_exp_f32 v141, v141
    v_mfma_f32_16x16x32_bf16 v[40:43], a[160:163], v[156:159], v[40:43]
    v_cvt_pk_bf16_f32 v138, v140, v141
    v_mfma_f32_16x16x32_bf16 v[44:47], a[132:135], v[152:155], v[44:47]
    v_exp_f32 v142, v142
    v_mfma_f32_16x16x32_bf16 v[44:47], a[164:167], v[156:159], v[44:47]
    v_mfma_f32_16x16x32_bf16 v[48:51], a[136:139], v[152:155], v[48:51]
    v_exp_f32 v143, v143
    v_mfma_f32_16x16x32_bf16 v[48:51], a[168:171], v[156:159], v[48:51]
    v_cvt_pk_bf16_f32 v139, v142, v143
    v_mfma_f32_16x16x32_bf16 v[52:55], a[140:143], v[152:155], v[52:55]
    v_exp_f32 v144, v144
    v_mfma_f32_16x16x32_bf16 v[52:55], a[172:175], v[156:159], v[52:55]
    v_mfma_f32_16x16x32_bf16 v[56:59], a[144:147], v[152:155], v[56:59]
    v_exp_f32 v145, v145
    v_mfma_f32_16x16x32_bf16 v[56:59], a[176:179], v[156:159], v[56:59]
    v_cvt_pk_bf16_f32 v140, v144, v145
    v_mfma_f32_16x16x32_bf16 v[60:63], a[148:151], v[152:155], v[60:63]
    v_exp_f32 v146, v146
    v_mfma_f32_16x16x32_bf16 v[60:63], a[180:183], v[156:159], v[60:63]
    v_mfma_f32_16x16x32_bf16 v[64:67], a[152:155], v[152:155], v[64:67]
    v_exp_f32 v147, v147
    v_mfma_f32_16x16x32_bf16 v[64:67], a[184:187], v[156:159], v[64:67]
    v_cvt_pk_bf16_f32 v141, v146, v147
    v_mfma_f32_16x16x32_bf16 v[68:71], a[156:159], v[152:155], v[68:71]
    v_exp_f32 v148, v148
    v_mfma_f32_16x16x32_bf16 v[68:71], a[188:191], v[156:159], v[68:71]
    v_mfma_f32_16x16x32_bf16 v[152:155], a[64:67], a[48:51], v[212:215]
    s_waitcnt vmcnt(0)
    s_barrier
    v_mfma_f32_16x16x32_bf16 v[152:155], a[68:71], a[52:55], v[152:155]
    v_exp_f32 v149, v149
    v_mfma_f32_16x16x32_bf16 v[152:155], a[72:75], a[56:59], v[152:155]
    ds_read_b128 a[64:67], v216 offset:49152
    v_cvt_pk_bf16_f32 v142, v148, v149
    v_mfma_f32_16x16x32_bf16 v[152:155], a[76:79], a[60:63], v[152:155]
    v_exp_f32 v150, v150
    v_mfma_f32_16x16x32_bf16 v[156:159], a[92:95], a[60:63], v[212:215]
    ds_read_b128 a[68:71], v217 offset:49152
    ds_read_b128 a[72:75], v218 offset:49152
    v_mfma_f32_16x16x32_bf16 v[156:159], a[88:91], a[56:59], v[156:159]
    v_exp_f32 v151, v151
    v_mfma_f32_16x16x32_bf16 v[156:159], a[84:87], a[52:55], v[156:159]
    ds_read_b128 a[76:79], v219 offset:49152
    v_cvt_pk_bf16_f32 v143, v150, v151
    v_mfma_f32_16x16x32_bf16 v[156:159], a[80:83], a[48:51], v[156:159]
    v_exp_f32 v152, v152
    v_mfma_f32_16x16x32_bf16 v[160:163], a[96:99], a[48:51], v[212:215]
    ds_read_b128 a[92:95], v219 offset:53248
    ds_read_b128 a[88:91], v218 offset:53248
    v_mfma_f32_16x16x32_bf16 v[160:163], a[100:103], a[52:55], v[160:163]
    v_exp_f32 v153, v153
    v_mfma_f32_16x16x32_bf16 v[160:163], a[104:107], a[56:59], v[160:163]
    ds_read_b128 a[84:87], v217 offset:53248
    v_cvt_pk_bf16_f32 v152, v152, v153
    v_mfma_f32_16x16x32_bf16 v[160:163], a[108:111], a[60:63], v[160:163]
    v_exp_f32 v154, v154
    v_mfma_f32_16x16x32_bf16 v[164:167], a[124:127], a[60:63], v[212:215]
    ds_read_b128 a[80:83], v216 offset:53248
    ds_read_b128 a[96:99], v216 offset:57344
    v_mfma_f32_16x16x32_bf16 v[164:167], a[120:123], a[56:59], v[164:167]
    v_exp_f32 v155, v155
    v_mfma_f32_16x16x32_bf16 v[164:167], a[116:119], a[52:55], v[164:167]
    ds_read_b128 a[100:103], v217 offset:57344
    v_cvt_pk_bf16_f32 v153, v154, v155
    v_mfma_f32_16x16x32_bf16 v[164:167], a[112:115], a[48:51], v[164:167]
    v_exp_f32 v156, v156
    v_smfmac_f32_16x16x64_bf16 a[200:203], a[208:211], v[136:143], v168
    ds_read_b128 a[104:107], v218 offset:57344
    ds_read_b128 a[108:111], v219 offset:57344
    v_mfma_f32_16x16x32_bf16 v[72:75], a[128:131], v[136:139], v[72:75]
    v_exp_f32 v157, v157
    v_mfma_f32_16x16x32_bf16 v[72:75], a[160:163], v[140:143], v[72:75]
    ds_read_b128 a[124:127], v219 offset:61440
    v_cvt_pk_bf16_f32 v154, v156, v157
    v_mfma_f32_16x16x32_bf16 v[76:79], a[132:135], v[136:139], v[76:79]
    v_exp_f32 v158, v158
    v_mfma_f32_16x16x32_bf16 v[76:79], a[164:167], v[140:143], v[76:79]
    ds_read_b128 a[120:123], v218 offset:61440
    ds_read_b128 a[116:119], v217 offset:61440
    v_mfma_f32_16x16x32_bf16 v[80:83], a[136:139], v[136:139], v[80:83]
    v_exp_f32 v159, v159
    v_mfma_f32_16x16x32_bf16 v[80:83], a[168:171], v[140:143], v[80:83]
    ds_read_b128 a[112:115], v216 offset:61440
    v_cvt_pk_bf16_f32 v155, v158, v159
    v_mfma_f32_16x16x32_bf16 v[84:87], a[140:143], v[136:139], v[84:87]
    v_exp_f32 v160, v160
    v_mfma_f32_16x16x32_bf16 v[84:87], a[172:175], v[140:143], v[84:87]
    v_mfma_f32_16x16x32_bf16 v[88:91], a[144:147], v[136:139], v[88:91]
    v_exp_f32 v161, v161
    v_mfma_f32_16x16x32_bf16 v[88:91], a[176:179], v[140:143], v[88:91]
    v_cvt_pk_bf16_f32 v156, v160, v161
    v_mfma_f32_16x16x32_bf16 v[92:95], a[148:151], v[136:139], v[92:95]
    v_exp_f32 v162, v162
    v_mfma_f32_16x16x32_bf16 v[92:95], a[180:183], v[140:143], v[92:95]
    v_mfma_f32_16x16x32_bf16 v[96:99], a[152:155], v[136:139], v[96:99]
    v_exp_f32 v163, v163
    v_mfma_f32_16x16x32_bf16 v[96:99], a[184:187], v[140:143], v[96:99]
    v_cvt_pk_bf16_f32 v157, v162, v163
    v_mfma_f32_16x16x32_bf16 v[100:103], a[156:159], v[136:139], v[100:103]
    v_exp_f32 v164, v164
    v_mfma_f32_16x16x32_bf16 v[100:103], a[188:191], v[140:143], v[100:103]
    s_waitcnt lgkmcnt(0)
    v_mfma_f32_16x16x32_bf16 v[136:139], a[64:67], a[0:3], v[200:203]
    v_mfma_f32_16x16x32_bf16 v[136:139], a[68:71], a[4:7], v[136:139]
    v_exp_f32 v165, v165
    v_mfma_f32_16x16x32_bf16 v[136:139], a[72:75], a[8:11], v[136:139]
    v_cvt_pk_bf16_f32 v158, v164, v165
    v_mfma_f32_16x16x32_bf16 v[136:139], a[76:79], a[12:15], v[136:139]
    v_exp_f32 v166, v166
    v_mfma_f32_16x16x32_bf16 v[140:143], a[92:95], a[12:15], v[200:203]
    s_nop 0
    v_mfma_f32_16x16x32_bf16 v[140:143], a[88:91], a[8:11], v[140:143]
    v_exp_f32 v167, v167
    v_mfma_f32_16x16x32_bf16 v[140:143], a[84:87], a[4:7], v[140:143]
    v_cvt_pk_bf16_f32 v159, v166, v167
    v_mfma_f32_16x16x32_bf16 v[140:143], a[80:83], a[0:3], v[140:143]
    v_exp_f32 v136, v136
    v_mfma_f32_16x16x32_bf16 v[144:147], a[96:99], a[0:3], v[200:203]
    v_mfma_f32_16x16x32_bf16 v[144:147], a[100:103], a[4:7], v[144:147]
    v_exp_f32 v137, v137
    v_mfma_f32_16x16x32_bf16 v[144:147], a[104:107], a[8:11], v[144:147]
    v_cvt_pk_bf16_f32 v136, v136, v137
    v_mfma_f32_16x16x32_bf16 v[144:147], a[108:111], a[12:15], v[144:147]
    v_exp_f32 v138, v138
    v_mfma_f32_16x16x32_bf16 v[148:151], a[124:127], a[12:15], v[200:203]
    v_mfma_f32_16x16x32_bf16 v[148:151], a[120:123], a[8:11], v[148:151]
    v_exp_f32 v139, v139
    v_mfma_f32_16x16x32_bf16 v[148:151], a[116:119], a[4:7], v[148:151]
    v_cvt_pk_bf16_f32 v137, v138, v139
    v_mfma_f32_16x16x32_bf16 v[148:151], a[112:115], a[0:3], v[148:151]
    v_exp_f32 v140, v140
    v_smfmac_f32_16x16x64_bf16 a[204:207], a[208:211], v[152:159], v168
    v_mfma_f32_16x16x32_bf16 v[104:107], a[128:131], v[152:155], v[104:107]
    v_exp_f32 v141, v141
    v_mfma_f32_16x16x32_bf16 v[104:107], a[160:163], v[156:159], v[104:107]
    ds_read_b64_tr_b16 a[128:129], v220 offset:0
    v_cvt_pk_bf16_f32 v138, v140, v141
    v_mfma_f32_16x16x32_bf16 v[108:111], a[132:135], v[152:155], v[108:111]
    v_exp_f32 v142, v142
    v_mfma_f32_16x16x32_bf16 v[108:111], a[164:167], v[156:159], v[108:111]
    ds_read_b64_tr_b16 a[130:131], v220 offset:4096
    ds_read_b64_tr_b16 a[160:161], v220 offset:8192
    v_mfma_f32_16x16x32_bf16 v[112:115], a[136:139], v[152:155], v[112:115]
    v_exp_f32 v143, v143
    v_mfma_f32_16x16x32_bf16 v[112:115], a[168:171], v[156:159], v[112:115]
    ds_read_b64_tr_b16 a[162:163], v220 offset:12288
    v_cvt_pk_bf16_f32 v139, v142, v143
    v_mfma_f32_16x16x32_bf16 v[116:119], a[140:143], v[152:155], v[116:119]
    v_exp_f32 v144, v144
    v_mfma_f32_16x16x32_bf16 v[116:119], a[172:175], v[156:159], v[116:119]
    ds_read_b64_tr_b16 a[132:133], v221 offset:0
    ds_read_b64_tr_b16 a[134:135], v221 offset:4096
    v_mfma_f32_16x16x32_bf16 v[120:123], a[144:147], v[152:155], v[120:123]
    v_exp_f32 v145, v145
    v_mfma_f32_16x16x32_bf16 v[120:123], a[176:179], v[156:159], v[120:123]
    ds_read_b64_tr_b16 a[164:165], v221 offset:8192
    v_cvt_pk_bf16_f32 v140, v144, v145
    v_mfma_f32_16x16x32_bf16 v[124:127], a[148:151], v[152:155], v[124:127]
    v_exp_f32 v146, v146
    v_mfma_f32_16x16x32_bf16 v[124:127], a[180:183], v[156:159], v[124:127]
    ds_read_b64_tr_b16 a[166:167], v221 offset:12288
    ds_read_b64_tr_b16 a[136:137], v222 offset:0
    v_mfma_f32_16x16x32_bf16 v[128:131], a[152:155], v[152:155], v[128:131]
    v_exp_f32 v147, v147
    v_mfma_f32_16x16x32_bf16 v[128:131], a[184:187], v[156:159], v[128:131]
    ds_read_b64_tr_b16 a[138:139], v222 offset:4096
    v_cvt_pk_bf16_f32 v141, v146, v147
    v_mfma_f32_16x16x32_bf16 v[132:135], a[156:159], v[152:155], v[132:135]
    v_exp_f32 v148, v148
    v_mfma_f32_16x16x32_bf16 v[132:135], a[188:191], v[156:159], v[132:135]
    ds_read_b64_tr_b16 a[168:169], v222 offset:8192
    ds_read_b64_tr_b16 a[170:171], v222 offset:12288
    v_mfma_f32_16x16x32_bf16 v[152:155], a[64:67], a[16:19], v[204:207]
    ds_read_b64_tr_b16 a[140:141], v223 offset:0
    v_mfma_f32_16x16x32_bf16 v[152:155], a[68:71], a[20:23], v[152:155]
    v_exp_f32 v149, v149
    v_mfma_f32_16x16x32_bf16 v[152:155], a[72:75], a[24:27], v[152:155]
    ds_read_b64_tr_b16 a[142:143], v223 offset:4096
    v_cvt_pk_bf16_f32 v142, v148, v149
    v_mfma_f32_16x16x32_bf16 v[152:155], a[76:79], a[28:31], v[152:155]
    v_exp_f32 v150, v150
    v_mfma_f32_16x16x32_bf16 v[156:159], a[92:95], a[28:31], v[204:207]
    ds_read_b64_tr_b16 a[172:173], v223 offset:8192
    ds_read_b64_tr_b16 a[174:175], v223 offset:12288
    v_mfma_f32_16x16x32_bf16 v[156:159], a[88:91], a[24:27], v[156:159]
    v_exp_f32 v151, v151
    v_mfma_f32_16x16x32_bf16 v[156:159], a[84:87], a[20:23], v[156:159]
    ds_read_b64_tr_b16 a[144:145], v224 offset:0
    v_cvt_pk_bf16_f32 v143, v150, v151
    v_mfma_f32_16x16x32_bf16 v[156:159], a[80:83], a[16:19], v[156:159]
    v_exp_f32 v152, v152
    v_mfma_f32_16x16x32_bf16 v[160:163], a[96:99], a[16:19], v[204:207]
    ds_read_b64_tr_b16 a[146:147], v224 offset:4096
    ds_read_b64_tr_b16 a[176:177], v224 offset:8192
    v_mfma_f32_16x16x32_bf16 v[160:163], a[100:103], a[20:23], v[160:163]
    v_exp_f32 v153, v153
    v_mfma_f32_16x16x32_bf16 v[160:163], a[104:107], a[24:27], v[160:163]
    ds_read_b64_tr_b16 a[178:179], v224 offset:12288
    v_cvt_pk_bf16_f32 v152, v152, v153
    v_mfma_f32_16x16x32_bf16 v[160:163], a[108:111], a[28:31], v[160:163]
    v_exp_f32 v154, v154
    v_mfma_f32_16x16x32_bf16 v[164:167], a[124:127], a[28:31], v[204:207]
    ds_read_b64_tr_b16 a[148:149], v225 offset:0
    ds_read_b64_tr_b16 a[150:151], v225 offset:4096
    v_mfma_f32_16x16x32_bf16 v[164:167], a[120:123], a[24:27], v[164:167]
    v_exp_f32 v155, v155
    v_mfma_f32_16x16x32_bf16 v[164:167], a[116:119], a[20:23], v[164:167]
    ds_read_b64_tr_b16 a[180:181], v225 offset:8192
    v_cvt_pk_bf16_f32 v153, v154, v155
    v_mfma_f32_16x16x32_bf16 v[164:167], a[112:115], a[16:19], v[164:167]
    v_exp_f32 v156, v156
    v_smfmac_f32_16x16x64_bf16 a[192:195], a[208:211], v[136:143], v168
    s_waitcnt lgkmcnt(2)
    ds_read_b64_tr_b16 a[182:183], v225 offset:12288
    ds_read_b64_tr_b16 a[152:153], v226 offset:0
    v_mfma_f32_16x16x32_bf16 v[8:11], a[128:131], v[136:139], v[8:11]
    v_exp_f32 v157, v157
    v_mfma_f32_16x16x32_bf16 v[8:11], a[160:163], v[140:143], v[8:11]
    ds_read_b64_tr_b16 a[154:155], v226 offset:4096
    v_cvt_pk_bf16_f32 v154, v156, v157
    v_mfma_f32_16x16x32_bf16 v[12:15], a[132:135], v[136:139], v[12:15]
    v_exp_f32 v158, v158
    v_mfma_f32_16x16x32_bf16 v[12:15], a[164:167], v[140:143], v[12:15]
    ds_read_b64_tr_b16 a[184:185], v226 offset:8192
    ds_read_b64_tr_b16 a[186:187], v226 offset:12288
    v_mfma_f32_16x16x32_bf16 v[16:19], a[136:139], v[136:139], v[16:19]
    v_exp_f32 v159, v159
    v_mfma_f32_16x16x32_bf16 v[16:19], a[168:171], v[140:143], v[16:19]
    ds_read_b64_tr_b16 a[156:157], v227 offset:0
    v_cvt_pk_bf16_f32 v155, v158, v159
    v_mfma_f32_16x16x32_bf16 v[20:23], a[140:143], v[136:139], v[20:23]
    v_exp_f32 v160, v160
    v_mfma_f32_16x16x32_bf16 v[20:23], a[172:175], v[140:143], v[20:23]
    ds_read_b64_tr_b16 a[158:159], v227 offset:4096
    ds_read_b64_tr_b16 a[188:189], v227 offset:8192
    v_mfma_f32_16x16x32_bf16 v[24:27], a[144:147], v[136:139], v[24:27]
    v_exp_f32 v161, v161
    v_mfma_f32_16x16x32_bf16 v[24:27], a[176:179], v[140:143], v[24:27]
    s_waitcnt lgkmcnt(2)
    ds_read_b64_tr_b16 a[190:191], v227 offset:12288
    v_cvt_pk_bf16_f32 v156, v160, v161
    v_mfma_f32_16x16x32_bf16 v[28:31], a[148:151], v[136:139], v[28:31]
    v_exp_f32 v162, v162
    v_mfma_f32_16x16x32_bf16 v[28:31], a[180:183], v[140:143], v[28:31]
    v_mfma_f32_16x16x32_bf16 v[32:35], a[152:155], v[136:139], v[32:35]
    v_exp_f32 v163, v163
    v_mfma_f32_16x16x32_bf16 v[32:35], a[184:187], v[140:143], v[32:35]
    s_waitcnt lgkmcnt(1)
    v_cvt_pk_bf16_f32 v157, v162, v163
    v_mfma_f32_16x16x32_bf16 v[36:39], a[156:159], v[136:139], v[36:39]
    s_waitcnt lgkmcnt(0)
    v_exp_f32 v164, v164
    v_mfma_f32_16x16x32_bf16 v[36:39], a[188:191], v[140:143], v[36:39]
    v_mfma_f32_16x16x32_bf16 v[136:139], a[64:67], a[32:35], v[208:211]
    s_barrier
    v_accvgpr_read_b32 v244, a192
    v_accvgpr_read_b32 v249, a193
    v_add_f32 v244, v244, v249
    v_cmp_ngt_f32 vcc, s29, v244
    v_mfma_f32_16x16x32_bf16 v[136:139], a[68:71], a[36:39], v[136:139]
    v_rcp_f32 v248, v244
    v_exp_f32 v165, v165
    v_exp_f32 v166, v166
    v_mfma_f32_16x16x32_bf16 v[136:139], a[72:75], a[40:43], v[136:139]
    s_cbranch_vccnz L_slow
    v_cvt_pk_bf16_f32 v158, v164, v165
    v_exp_f32 v167, v167
    s_nop 0
    v_cvt_pk_bf16_f32 v159, v166, v167
    v_mfma_f32_16x16x32_bf16 v[136:139], a[76:79], a[44:47], v[136:139]
    v_mul_f32 v8, v8, v248
    v_mul_f32 v9, v9, v248
    v_mul_f32 v10, v10, v248
    v_mul_f32 v11, v11, v248
    v_mul_f32 v12, v12, v248
    v_mul_f32 v13, v13, v248
    v_mfma_f32_16x16x32_bf16 v[140:143], a[92:95], a[44:47], v[208:211]
    v_mul_f32 v14, v14, v248
    v_mul_f32 v15, v15, v248
    v_cvt_pk_bf16_f32 v8, v8, v9
    v_cvt_pk_bf16_f32 v9, v10, v11
    v_cvt_pk_bf16_f32 v10, v12, v13
    v_cvt_pk_bf16_f32 v11, v14, v15
    v_mfma_f32_16x16x32_bf16 v[140:143], a[88:91], a[40:43], v[140:143]
    ds_write2_b64 v234, v[8:9], v[10:11] offset0:0 offset1:4
    v_mul_f32 v16, v16, v248
    v_mul_f32 v17, v17, v248
    v_mul_f32 v18, v18, v248
    v_mul_f32 v19, v19, v248
    v_mul_f32 v20, v20, v248
    v_mfma_f32_16x16x32_bf16 v[140:143], a[84:87], a[36:39], v[140:143]
    v_exp_f32 v136, v136
    v_mul_f32 v21, v21, v248
    v_mul_f32 v22, v22, v248
    v_mul_f32 v23, v23, v248
    v_cvt_pk_bf16_f32 v16, v16, v17
    v_mfma_f32_16x16x32_bf16 v[140:143], a[80:83], a[32:35], v[140:143]
    v_exp_f32 v137, v137
    v_cvt_pk_bf16_f32 v17, v18, v19
    v_cvt_pk_bf16_f32 v18, v20, v21
    v_cvt_pk_bf16_f32 v19, v22, v23
    v_mfma_f32_16x16x32_bf16 v[144:147], a[96:99], a[32:35], v[208:211]
    ds_write2_b64 v234, v[16:17], v[18:19] offset0:8 offset1:12
    v_exp_f32 v138, v138
    v_mul_f32 v24, v24, v248
    v_mul_f32 v25, v25, v248
    v_mul_f32 v26, v26, v248
    v_mfma_f32_16x16x32_bf16 v[144:147], a[100:103], a[36:39], v[144:147]
    ds_read_b128 v[12:15], v238 offset:0
    ds_read_b128 v[20:23], v238 offset:2176
    v_cvt_pk_bf16_f32 v136, v136, v137
    v_mul_f32 v27, v27, v248
    v_mul_f32 v28, v28, v248
    v_mul_f32 v29, v29, v248
    v_mul_f32 v30, v30, v248
    v_mul_f32 v31, v31, v248
    v_mfma_f32_16x16x32_bf16 v[144:147], a[104:107], a[40:43], v[144:147]
    v_exp_f32 v139, v139
    v_cvt_pk_bf16_f32 v24, v24, v25
    v_cvt_pk_bf16_f32 v25, v26, v27
    v_cvt_pk_bf16_f32 v26, v28, v29
    v_cvt_pk_bf16_f32 v27, v30, v31
    v_mfma_f32_16x16x32_bf16 v[144:147], a[108:111], a[44:47], v[144:147]
    ds_write2_b64 v234, v[24:25], v[26:27] offset0:16 offset1:20
    v_exp_f32 v140, v140
    v_mul_f32 v32, v32, v248
    v_mul_f32 v33, v33, v248
    v_mul_f32 v34, v34, v248
    v_mfma_f32_16x16x32_bf16 v[148:151], a[124:127], a[44:47], v[208:211]
    s_waitcnt lgkmcnt(1)
    buffer_store_dwordx4 v[12:15], v240, s[16:19], 0 offen offset:0 nt
    v_cvt_pk_bf16_f32 v137, v138, v139
    v_mul_f32 v35, v35, v248
    v_mul_f32 v36, v36, v248
    v_mul_f32 v37, v37, v248
    v_mul_f32 v38, v38, v248
    v_mul_f32 v39, v39, v248
    v_mfma_f32_16x16x32_bf16 v[148:151], a[120:123], a[40:43], v[148:151]
    v_exp_f32 v141, v141
    v_cvt_pk_bf16_f32 v32, v32, v33
    v_cvt_pk_bf16_f32 v33, v34, v35
    v_cvt_pk_bf16_f32 v34, v36, v37
    v_cvt_pk_bf16_f32 v35, v38, v39
    v_mfma_f32_16x16x32_bf16 v[148:151], a[116:119], a[36:39], v[148:151]
    ds_write2_b64 v234, v[32:33], v[34:35] offset0:24 offset1:28
    v_exp_f32 v142, v142
    v_mfma_f32_16x16x32_bf16 v[148:151], a[112:115], a[32:35], v[148:151]
    ds_read_b128 v[28:31], v238 offset:128
    ds_read_b128 v[36:39], v238 offset:2304
    v_cvt_pk_bf16_f32 v138, v140, v141
    v_smfmac_f32_16x16x64_bf16 a[196:199], a[208:211], v[152:159], v168
    buffer_store_dwordx4 v[20:23], v240, s[16:19], 0 offen offset:2048 nt
    v_exp_f32 v143, v143
    v_mfma_f32_16x16x32_bf16 v[40:43], a[128:131], v[152:155], v[40:43]
    v_exp_f32 v144, v144
    v_mfma_f32_16x16x32_bf16 v[40:43], a[160:163], v[156:159], v[40:43]
    v_cvt_pk_bf16_f32 v139, v142, v143
    v_mfma_f32_16x16x32_bf16 v[44:47], a[132:135], v[152:155], v[44:47]
    v_exp_f32 v145, v145
    v_mfma_f32_16x16x32_bf16 v[44:47], a[164:167], v[156:159], v[44:47]
    s_nop 2
    v_accvgpr_read_b32 v245, a196
    v_accvgpr_read_b32 v251, a197
    v_add_f32 v245, v245, v251
    v_cmp_ngt_f32 vcc, s29, v245
    v_rcp_f32 v250, v245
    v_mfma_f32_16x16x32_bf16 v[48:51], a[136:139], v[152:155], v[48:51]
    s_cbranch_vccnz L_slow
    v_exp_f32 v146, v146
    v_cvt_pk_bf16_f32 v140, v144, v145
    v_mfma_f32_16x16x32_bf16 v[48:51], a[168:171], v[156:159], v[48:51]
    s_waitcnt lgkmcnt(0)
    buffer_store_dwordx4 v[28:31], v240, s[16:19], 0 offen offset:128 nt
    v_exp_f32 v147, v147
    v_mfma_f32_16x16x32_bf16 v[52:55], a[140:143], v[152:155], v[52:55]
    v_exp_f32 v148, v148
    v_mul_f32 v40, v40, v250
    v_mul_f32 v41, v41, v250
    v_mul_f32 v42, v42, v250
    v_mul_f32 v43, v43, v250
    v_mfma_f32_16x16x32_bf16 v[52:55], a[172:175], v[156:159], v[52:55]
    v_cvt_pk_bf16_f32 v141, v146, v147
    v_mul_f32 v44, v44, v250
    v_mul_f32 v45, v45, v250
    v_mul_f32 v46, v46, v250
    v_mul_f32 v47, v47, v250
    v_cvt_pk_bf16_f32 v40, v40, v41
    v_mfma_f32_16x16x32_bf16 v[56:59], a[144:147], v[152:155], v[56:59]
    buffer_store_dwordx4 v[36:39], v240, s[16:19], 0 offen offset:2176 nt
    v_exp_f32 v149, v149
    v_cvt_pk_bf16_f32 v41, v42, v43
    v_cvt_pk_bf16_f32 v42, v44, v45
    v_cvt_pk_bf16_f32 v43, v46, v47
    v_mfma_f32_16x16x32_bf16 v[56:59], a[176:179], v[156:159], v[56:59]
    ds_write2_b64 v235, v[40:41], v[42:43] offset0:0 offset1:4
    v_exp_f32 v150, v150
    v_mfma_f32_16x16x32_bf16 v[60:63], a[148:151], v[152:155], v[60:63]
    v_cvt_pk_bf16_f32 v142, v148, v149
    v_mul_f32 v48, v48, v250
    v_mul_f32 v49, v49, v250
    v_mul_f32 v50, v50, v250
    v_mul_f32 v51, v51, v250
    v_mul_f32 v52, v52, v250
    v_mfma_f32_16x16x32_bf16 v[60:63], a[180:183], v[156:159], v[60:63]
    v_exp_f32 v151, v151
    v_mul_f32 v53, v53, v250
    v_mul_f32 v54, v54, v250
    v_mul_f32 v55, v55, v250
    v_cvt_pk_bf16_f32 v48, v48, v49
    v_mfma_f32_16x16x32_bf16 v[64:67], a[152:155], v[152:155], v[64:67]
    s_nop 0
    v_cvt_pk_bf16_f32 v49, v50, v51
    v_cvt_pk_bf16_f32 v50, v52, v53
    v_cvt_pk_bf16_f32 v51, v54, v55
    v_mfma_f32_16x16x32_bf16 v[64:67], a[184:187], v[156:159], v[64:67]
    ds_write2_b64 v235, v[48:49], v[50:51] offset0:8 offset1:12
    v_cvt_pk_bf16_f32 v143, v150, v151
    v_mfma_f32_16x16x32_bf16 v[68:71], a[156:159], v[152:155], v[68:71]
    ds_read_b128 v[44:47], v238 offset:4352
    ds_read_b128 v[52:55], v238 offset:6528
    v_mul_f32 v56, v56, v250
    v_mul_f32 v57, v57, v250
    v_mul_f32 v58, v58, v250
    v_mul_f32 v59, v59, v250
    v_mul_f32 v60, v60, v250
    v_mul_f32 v61, v61, v250
    v_mfma_f32_16x16x32_bf16 v[68:71], a[188:191], v[156:159], v[68:71]
    v_mul_f32 v62, v62, v250
    v_mul_f32 v63, v63, v250
    v_cvt_pk_bf16_f32 v56, v56, v57
    v_cvt_pk_bf16_f32 v57, v58, v59
    v_cvt_pk_bf16_f32 v58, v60, v61
    v_cvt_pk_bf16_f32 v59, v62, v63
    v_mfma_f32_16x16x32_bf16 v[152:155], a[64:67], a[48:51], v[212:215]
    ds_write2_b64 v235, v[56:57], v[58:59] offset0:16 offset1:20
    v_mfma_f32_16x16x32_bf16 v[152:155], a[68:71], a[52:55], v[152:155]
    s_waitcnt lgkmcnt(1)
    buffer_store_dwordx4 v[44:47], v240, s[16:19], s81 offen offset:0 nt
    v_mfma_f32_16x16x32_bf16 v[152:155], a[72:75], a[56:59], v[152:155]
    v_mul_f32 v64, v64, v250
    v_mul_f32 v65, v65, v250
    v_mul_f32 v66, v66, v250
    v_mul_f32 v67, v67, v250
    v_mul_f32 v68, v68, v250
    v_mul_f32 v69, v69, v250
    v_mfma_f32_16x16x32_bf16 v[152:155], a[76:79], a[60:63], v[152:155]
    v_mul_f32 v70, v70, v250
    v_mul_f32 v71, v71, v250
    v_cvt_pk_bf16_f32 v64, v64, v65
    v_cvt_pk_bf16_f32 v65, v66, v67
    v_cvt_pk_bf16_f32 v66, v68, v69
    v_cvt_pk_bf16_f32 v67, v70, v71
    v_mfma_f32_16x16x32_bf16 v[156:159], a[92:95], a[60:63], v[212:215]
    ds_write2_b64 v235, v[64:65], v[66:67] offset0:24 offset1:28
    v_mfma_f32_16x16x32_bf16 v[156:159], a[88:91], a[56:59], v[156:159]
    ds_read_b128 v[60:63], v238 offset:4480
    ds_read_b128 v[68:71], v238 offset:6656
    v_mfma_f32_16x16x32_bf16 v[156:159], a[84:87], a[52:55], v[156:159]
    buffer_store_dwordx4 v[52:55], v240, s[16:19], s81 offen offset:2048 nt
    v_exp_f32 v152, v152
    v_mfma_f32_16x16x32_bf16 v[156:159], a[80:83], a[48:51], v[156:159]
    v_exp_f32 v153, v153
    v_mfma_f32_16x16x32_bf16 v[160:163], a[96:99], a[48:51], v[212:215]
    v_exp_f32 v154, v154
    v_mfma_f32_16x16x32_bf16 v[160:163], a[100:103], a[52:55], v[160:163]
    v_cvt_pk_bf16_f32 v152, v152, v153
    v_mfma_f32_16x16x32_bf16 v[160:163], a[104:107], a[56:59], v[160:163]
    v_exp_f32 v155, v155
    v_mfma_f32_16x16x32_bf16 v[160:163], a[108:111], a[60:63], v[160:163]
    v_exp_f32 v156, v156
    v_mfma_f32_16x16x32_bf16 v[164:167], a[124:127], a[60:63], v[212:215]
    s_waitcnt lgkmcnt(0)
    buffer_store_dwordx4 v[60:63], v240, s[16:19], s81 offen offset:128 nt
    v_cvt_pk_bf16_f32 v153, v154, v155
    v_mfma_f32_16x16x32_bf16 v[164:167], a[120:123], a[56:59], v[164:167]
    v_exp_f32 v157, v157
    v_mfma_f32_16x16x32_bf16 v[164:167], a[116:119], a[52:55], v[164:167]
    v_exp_f32 v158, v158
    v_mfma_f32_16x16x32_bf16 v[164:167], a[112:115], a[48:51], v[164:167]
    v_cvt_pk_bf16_f32 v154, v156, v157
    v_smfmac_f32_16x16x64_bf16 a[200:203], a[208:211], v[136:143], v168
    v_exp_f32 v159, v159
    v_mfma_f32_16x16x32_bf16 v[72:75], a[128:131], v[136:139], v[72:75]
    buffer_store_dwordx4 v[68:71], v240, s[16:19], s81 offen offset:2176 nt
    v_exp_f32 v160, v160
    v_mfma_f32_16x16x32_bf16 v[72:75], a[160:163], v[140:143], v[72:75]
    v_cvt_pk_bf16_f32 v155, v158, v159
    v_mfma_f32_16x16x32_bf16 v[76:79], a[132:135], v[136:139], v[76:79]
    v_exp_f32 v161, v161
    v_mfma_f32_16x16x32_bf16 v[76:79], a[164:167], v[140:143], v[76:79]
    s_nop 2
    v_accvgpr_read_b32 v246, a200
    v_accvgpr_read_b32 v253, a201
    v_add_f32 v246, v246, v253
    v_cmp_ngt_f32 vcc, s29, v246
    v_rcp_f32 v252, v246
    v_mfma_f32_16x16x32_bf16 v[80:83], a[136:139], v[136:139], v[80:83]
    s_cbranch_vccnz L_slow
    v_exp_f32 v162, v162
    v_cvt_pk_bf16_f32 v156, v160, v161
    v_mfma_f32_16x16x32_bf16 v[80:83], a[168:171], v[140:143], v[80:83]
    v_exp_f32 v163, v163
    v_mfma_f32_16x16x32_bf16 v[84:87], a[140:143], v[136:139], v[84:87]
    v_exp_f32 v164, v164
    v_mul_f32 v72, v72, v252
    v_mul_f32 v73, v73, v252
    v_mul_f32 v74, v74, v252
    v_mul_f32 v75, v75, v252
    v_mfma_f32_16x16x32_bf16 v[84:87], a[172:175], v[140:143], v[84:87]
    v_cvt_pk_bf16_f32 v157, v162, v163
    v_mul_f32 v76, v76, v252
    v_mul_f32 v77, v77, v252
    v_mul_f32 v78, v78, v252
    v_mul_f32 v79, v79, v252
    v_cvt_pk_bf16_f32 v72, v72, v73
    v_mfma_f32_16x16x32_bf16 v[88:91], a[144:147], v[136:139], v[88:91]
    v_exp_f32 v165, v165
    v_cvt_pk_bf16_f32 v73, v74, v75
    v_cvt_pk_bf16_f32 v74, v76, v77
    v_cvt_pk_bf16_f32 v75, v78, v79
    v_mfma_f32_16x16x32_bf16 v[88:91], a[176:179], v[140:143], v[88:91]
    ds_write2_b64 v236, v[72:73], v[74:75] offset0:0 offset1:4
    v_exp_f32 v166, v166
    v_mfma_f32_16x16x32_bf16 v[92:95], a[148:151], v[136:139], v[92:95]
    v_cvt_pk_bf16_f32 v158, v164, v165
    v_mul_f32 v80, v80, v252
    v_mul_f32 v81, v81, v252
    v_mul_f32 v82, v82, v252
    v_mul_f32 v83, v83, v252
    v_mul_f32 v84, v84, v252
    v_mfma_f32_16x16x32_bf16 v[92:95], a[180:183], v[140:143], v[92:95]
    v_exp_f32 v167, v167
    v_mul_f32 v85, v85, v252
    v_mul_f32 v86, v86, v252
    v_mul_f32 v87, v87, v252
    v_cvt_pk_bf16_f32 v80, v80, v81
    v_mfma_f32_16x16x32_bf16 v[96:99], a[152:155], v[136:139], v[96:99]
    s_nop 0
    v_cvt_pk_bf16_f32 v81, v82, v83
    v_cvt_pk_bf16_f32 v82, v84, v85
    v_cvt_pk_bf16_f32 v83, v86, v87
    v_mfma_f32_16x16x32_bf16 v[96:99], a[184:187], v[140:143], v[96:99]
    ds_write2_b64 v236, v[80:81], v[82:83] offset0:8 offset1:12
    v_cvt_pk_bf16_f32 v159, v166, v167
    v_mfma_f32_16x16x32_bf16 v[100:103], a[156:159], v[136:139], v[100:103]
    ds_read_b128 v[76:79], v238 offset:8704
    ds_read_b128 v[84:87], v238 offset:10880
    v_mul_f32 v88, v88, v252
    v_mul_f32 v89, v89, v252
    v_mul_f32 v90, v90, v252
    v_mul_f32 v91, v91, v252
    v_mul_f32 v92, v92, v252
    v_mul_f32 v93, v93, v252
    v_mfma_f32_16x16x32_bf16 v[100:103], a[188:191], v[140:143], v[100:103]
    v_mul_f32 v94, v94, v252
    v_mul_f32 v95, v95, v252
    v_cvt_pk_bf16_f32 v88, v88, v89
    v_cvt_pk_bf16_f32 v89, v90, v91
    v_cvt_pk_bf16_f32 v90, v92, v93
    v_cvt_pk_bf16_f32 v91, v94, v95
    v_smfmac_f32_16x16x64_bf16 a[204:207], a[208:211], v[152:159], v168
    ds_write2_b64 v236, v[88:89], v[90:91] offset0:16 offset1:20
    v_mfma_f32_16x16x32_bf16 v[104:107], a[128:131], v[152:155], v[104:107]
    s_waitcnt lgkmcnt(1)
    buffer_store_dwordx4 v[76:79], v240, s[16:19], s82 offen offset:0 nt
    v_mfma_f32_16x16x32_bf16 v[104:107], a[160:163], v[156:159], v[104:107]
    v_mul_f32 v96, v96, v252
    v_mul_f32 v97, v97, v252
    v_mul_f32 v98, v98, v252
    v_mul_f32 v99, v99, v252
    v_mul_f32 v100, v100, v252
    v_mul_f32 v101, v101, v252
    v_mfma_f32_16x16x32_bf16 v[108:111], a[132:135], v[152:155], v[108:111]
    v_mul_f32 v102, v102, v252
    v_mul_f32 v103, v103, v252
    v_cvt_pk_bf16_f32 v96, v96, v97
    v_cvt_pk_bf16_f32 v97, v98, v99
    v_cvt_pk_bf16_f32 v98, v100, v101
    v_cvt_pk_bf16_f32 v99, v102, v103
    v_mfma_f32_16x16x32_bf16 v[108:111], a[164:167], v[156:159], v[108:111]
    ds_write2_b64 v236, v[96:97], v[98:99] offset0:24 offset1:28
    v_accvgpr_read_b32 v247, a204
    v_accvgpr_read_b32 v255, a205
    v_add_f32 v247, v247, v255
    v_cmp_ngt_f32 vcc, s29, v247
    v_mfma_f32_16x16x32_bf16 v[112:115], a[136:139], v[152:155], v[112:115]
    ds_read_b128 v[92:95], v238 offset:8832
    ds_read_b128 v[100:103], v238 offset:11008
    v_rcp_f32 v254, v247
    v_mfma_f32_16x16x32_bf16 v[112:115], a[168:171], v[156:159], v[112:115]
    s_cbranch_vccnz L_slow
    v_mfma_f32_16x16x32_bf16 v[116:119], a[140:143], v[152:155], v[116:119]
    buffer_store_dwordx4 v[84:87], v240, s[16:19], s82 offen offset:2048 nt
    v_mul_f32 v104, v104, v254
    v_mul_f32 v105, v105, v254
    v_mul_f32 v106, v106, v254
    v_mul_f32 v107, v107, v254
    v_mul_f32 v108, v108, v254
    v_mul_f32 v109, v109, v254
    v_mfma_f32_16x16x32_bf16 v[116:119], a[172:175], v[156:159], v[116:119]
    v_mul_f32 v110, v110, v254
    v_mul_f32 v111, v111, v254
    v_cvt_pk_bf16_f32 v104, v104, v105
    v_cvt_pk_bf16_f32 v105, v106, v107
    v_cvt_pk_bf16_f32 v106, v108, v109
    v_cvt_pk_bf16_f32 v107, v110, v111
    v_mfma_f32_16x16x32_bf16 v[120:123], a[144:147], v[152:155], v[120:123]
    ds_write2_b64 v237, v[104:105], v[106:107] offset0:0 offset1:4
    v_mfma_f32_16x16x32_bf16 v[120:123], a[176:179], v[156:159], v[120:123]
    s_waitcnt lgkmcnt(1)
    buffer_store_dwordx4 v[92:95], v240, s[16:19], s82 offen offset:128 nt
    v_mfma_f32_16x16x32_bf16 v[124:127], a[148:151], v[152:155], v[124:127]
    v_mul_f32 v112, v112, v254
    v_mul_f32 v113, v113, v254
    v_mul_f32 v114, v114, v254
    v_mul_f32 v115, v115, v254
    v_mul_f32 v116, v116, v254
    v_mul_f32 v117, v117, v254
    v_mfma_f32_16x16x32_bf16 v[124:127], a[180:183], v[156:159], v[124:127]
    v_mul_f32 v118, v118, v254
    v_mul_f32 v119, v119, v254
    v_cvt_pk_bf16_f32 v112, v112, v113
    v_cvt_pk_bf16_f32 v113, v114, v115
    v_cvt_pk_bf16_f32 v114, v116, v117
    v_cvt_pk_bf16_f32 v115, v118, v119
    v_mfma_f32_16x16x32_bf16 v[128:131], a[152:155], v[152:155], v[128:131]
    ds_write2_b64 v237, v[112:113], v[114:115] offset0:8 offset1:12
    v_mfma_f32_16x16x32_bf16 v[128:131], a[184:187], v[156:159], v[128:131]
    ds_read_b128 v[108:111], v238 offset:13056
    ds_read_b128 v[116:119], v238 offset:15232
    v_mfma_f32_16x16x32_bf16 v[132:135], a[156:159], v[152:155], v[132:135]
    buffer_store_dwordx4 v[100:103], v240, s[16:19], s82 offen offset:2176 nt
    v_mfma_f32_16x16x32_bf16 v[132:135], a[188:191], v[156:159], v[132:135]
    v_pk_mul_f32 v[120:121], v[120:121], v[254:255] op_sel_hi:[1,0]
    v_pk_mul_f32 v[122:123], v[122:123], v[254:255] op_sel_hi:[1,0]
    v_pk_mul_f32 v[124:125], v[124:125], v[254:255] op_sel_hi:[1,0]
    v_pk_mul_f32 v[126:127], v[126:127], v[254:255] op_sel_hi:[1,0]
    v_cvt_pk_bf16_f32 v120, v120, v121
    v_cvt_pk_bf16_f32 v121, v122, v123
    v_cvt_pk_bf16_f32 v122, v124, v125
    v_cvt_pk_bf16_f32 v123, v126, v127
    ds_write2_b64 v237, v[120:121], v[122:123] offset0:16 offset1:20
    v_pk_mul_f32 v[128:129], v[128:129], v[254:255] op_sel_hi:[1,0]
    v_pk_mul_f32 v[130:131], v[130:131], v[254:255] op_sel_hi:[1,0]
    s_waitcnt lgkmcnt(1)
    buffer_store_dwordx4 v[108:111], v240, s[16:19], s83 offen offset:0 nt
    v_pk_mul_f32 v[132:133], v[132:133], v[254:255] op_sel_hi:[1,0]
    v_pk_mul_f32 v[134:135], v[134:135], v[254:255] op_sel_hi:[1,0]
    v_cvt_pk_bf16_f32 v128, v128, v129
    v_cvt_pk_bf16_f32 v129, v130, v131
    v_cvt_pk_bf16_f32 v130, v132, v133
    v_cvt_pk_bf16_f32 v131, v134, v135
    ds_write2_b64 v237, v[128:129], v[130:131] offset0:24 offset1:28
    ds_read_b128 v[124:127], v238 offset:13184
    ds_read_b128 v[132:135], v238 offset:15360
    buffer_store_dwordx4 v[116:119], v240, s[16:19], s83 offen offset:2048 nt
    s_waitcnt lgkmcnt(1)
    buffer_store_dwordx4 v[124:127], v240, s[16:19], s83 offen offset:128 nt
    s_waitcnt lgkmcnt(0)
    buffer_store_dwordx4 v[132:135], v240, s[16:19], s83 offen offset:2176 nt
L_end:
L_done:
    s_endpgm
L_role1:
    s_mov_b32 s24, 0
    s_add_u32 m0, s22, 16384
    s_nop 0
    buffer_load_dwordx4 v232, s[12:15], s24 offen offset:0 lds
    buffer_load_dwordx4 v233, s[12:15], s24 offen offset:1024 lds
    buffer_load_dwordx4 v232, s[12:15], s24 offen offset:2048 lds
    buffer_load_dwordx4 v233, s[12:15], s24 offen offset:3072 lds
    s_waitcnt vmcnt(4)
    ds_read_b128 v[104:107], v244 offset:0
    ds_read_b128 v[108:111], v245 offset:0
    ds_read_b128 v[112:115], v246 offset:0
    ds_read_b128 v[116:119], v247 offset:0
    s_add_u32 m0, s33, 4096
    s_add_u32 s28, s84, 4096
    buffer_load_dwordx4 v228, s[4:7], s28 offen offset:0 lds
    s_waitcnt lgkmcnt(3)
    v_lshlrev_b32 v120, 16, v104
    v_and_b32 v121, s30, v104
    v_lshlrev_b32 v122, 16, v105
    v_and_b32 v123, s30, v105
    v_lshlrev_b32 v124, 16, v106
    v_and_b32 v125, s30, v106
    v_lshlrev_b32 v126, 16, v107
    v_and_b32 v127, s30, v107
    v_pk_mul_f32 v[120:121], v[120:121], s[26:27]
    v_pk_mul_f32 v[122:123], v[122:123], s[26:27]
    v_pk_mul_f32 v[124:125], v[124:125], s[26:27]
    v_pk_mul_f32 v[126:127], v[126:127], s[26:27]
    v_cvt_pk_bf16_f32 v120, v120, v121
    v_cvt_pk_bf16_f32 v122, v122, v123
    buffer_load_dwordx4 v229, s[4:7], s28 offen offset:1024 lds
    v_cvt_pk_bf16_f32 v124, v124, v125
    v_cvt_pk_bf16_f32 v126, v126, v127
    v_accvgpr_write_b32 a0, v120
    v_accvgpr_write_b32 a1, v122
    v_accvgpr_write_b32 a2, v124
    v_accvgpr_write_b32 a3, v126
    s_waitcnt lgkmcnt(0)
    v_lshlrev_b32 v128, 16, v108
    v_and_b32 v129, s30, v108
    v_lshlrev_b32 v130, 16, v109
    v_and_b32 v131, s30, v109
    v_lshlrev_b32 v132, 16, v110
    v_and_b32 v133, s30, v110
    v_lshlrev_b32 v134, 16, v111
    v_and_b32 v135, s30, v111
    buffer_load_dwordx4 v230, s[4:7], s28 offen offset:2048 lds
    v_pk_mul_f32 v[128:129], v[128:129], s[26:27]
    v_pk_mul_f32 v[130:131], v[130:131], s[26:27]
    v_pk_mul_f32 v[132:133], v[132:133], s[26:27]
    v_pk_mul_f32 v[134:135], v[134:135], s[26:27]
    v_cvt_pk_bf16_f32 v128, v128, v129
    v_cvt_pk_bf16_f32 v130, v130, v131
    v_cvt_pk_bf16_f32 v132, v132, v133
    v_cvt_pk_bf16_f32 v134, v134, v135
    v_accvgpr_write_b32 a4, v128
    v_accvgpr_write_b32 a5, v130
    v_accvgpr_write_b32 a6, v132
    v_accvgpr_write_b32 a7, v134
    v_lshlrev_b32 v120, 16, v112
    v_and_b32 v121, s30, v112
    buffer_load_dwordx4 v231, s[4:7], s28 offen offset:3072 lds
    v_lshlrev_b32 v122, 16, v113
    v_and_b32 v123, s30, v113
    v_lshlrev_b32 v124, 16, v114
    v_and_b32 v125, s30, v114
    v_lshlrev_b32 v126, 16, v115
    v_and_b32 v127, s30, v115
    v_pk_mul_f32 v[120:121], v[120:121], s[26:27]
    v_pk_mul_f32 v[122:123], v[122:123], s[26:27]
    v_pk_mul_f32 v[124:125], v[124:125], s[26:27]
    v_pk_mul_f32 v[126:127], v[126:127], s[26:27]
    v_cvt_pk_bf16_f32 v120, v120, v121
    v_cvt_pk_bf16_f32 v122, v122, v123
    v_cvt_pk_bf16_f32 v124, v124, v125
    v_cvt_pk_bf16_f32 v126, v126, v127
    global_load_dwordx4 v[252:255], v[252:253], off
    v_accvgpr_write_b32 a8, v120
    v_accvgpr_write_b32 a9, v122
    v_accvgpr_write_b32 a10, v124
    v_accvgpr_write_b32 a11, v126
    v_lshlrev_b32 v128, 16, v116
    v_and_b32 v129, s30, v116
    v_lshlrev_b32 v130, 16, v117
    v_and_b32 v131, s30, v117
    v_lshlrev_b32 v132, 16, v118
    v_and_b32 v133, s30, v118
    v_lshlrev_b32 v134, 16, v119
    v_and_b32 v135, s30, v119
    v_pk_mul_f32 v[128:129], v[128:129], s[26:27]
    v_pk_mul_f32 v[130:131], v[130:131], s[26:27]
    v_pk_mul_f32 v[132:133], v[132:133], s[26:27]
    v_pk_mul_f32 v[134:135], v[134:135], s[26:27]
    v_cvt_pk_bf16_f32 v128, v128, v129
    v_cvt_pk_bf16_f32 v130, v130, v131
    v_cvt_pk_bf16_f32 v132, v132, v133
    v_cvt_pk_bf16_f32 v134, v134, v135
    v_accvgpr_write_b32 a12, v128
    v_accvgpr_write_b32 a13, v130
    v_accvgpr_write_b32 a14, v132
    v_accvgpr_write_b32 a15, v134
    s_barrier
    ds_read_b128 a[64:67], v216 offset:0
    ds_read_b128 a[80:83], v216 offset:4096
    ds_read_b128 a[96:99], v216 offset:8192
    ds_read_b128 a[112:115], v216 offset:12288
    ds_read_b128 a[68:71], v217 offset:0
    ds_read_b128 a[84:87], v217 offset:4096
    ds_read_b128 a[100:103], v217 offset:8192
    ds_read_b128 a[116:119], v217 offset:12288
    ds_read_b128 a[72:75], v218 offset:0
    ds_read_b128 a[88:91], v218 offset:4096
    ds_read_b128 a[104:107], v218 offset:8192
    ds_read_b128 a[120:123], v218 offset:12288
    s_waitcnt lgkmcnt(11)
    v_mfma_f32_16x16x32_bf16 v[136:139], a[64:67], a[0:3], 0
    s_waitcnt lgkmcnt(10)
    ds_read_b128 a[76:79], v219 offset:0
    ds_read_b128 a[92:95], v219 offset:4096
    ds_read_b128 a[108:111], v219 offset:8192
    ds_read_b128 a[124:127], v219 offset:12288
    v_mfma_f32_16x16x32_bf16 v[140:143], a[80:83], a[0:3], 0
    s_waitcnt lgkmcnt(13)
    v_mfma_f32_16x16x32_bf16 v[144:147], a[96:99], a[0:3], 0
    s_waitcnt lgkmcnt(12)
    v_mfma_f32_16x16x32_bf16 v[148:151], a[112:115], a[0:3], 0
    s_waitcnt lgkmcnt(11)
    v_mfma_f32_16x16x32_bf16 v[136:139], a[68:71], a[4:7], v[136:139]
    s_waitcnt lgkmcnt(10)
    v_mfma_f32_16x16x32_bf16 v[140:143], a[84:87], a[4:7], v[140:143]
    s_waitcnt lgkmcnt(9)
    v_mfma_f32_16x16x32_bf16 v[144:147], a[100:103], a[4:7], v[144:147]
    s_waitcnt lgkmcnt(8)
    v_mfma_f32_16x16x32_bf16 v[148:151], a[116:119], a[4:7], v[148:151]
    s_waitcnt lgkmcnt(7)
    v_mfma_f32_16x16x32_bf16 v[136:139], a[72:75], a[8:11], v[136:139]
    s_waitcnt lgkmcnt(6)
    v_mfma_f32_16x16x32_bf16 v[140:143], a[88:91], a[8:11], v[140:143]
    s_waitcnt lgkmcnt(5)
    v_mfma_f32_16x16x32_bf16 v[144:147], a[104:107], a[8:11], v[144:147]
    s_waitcnt lgkmcnt(4)
    v_mfma_f32_16x16x32_bf16 v[148:151], a[120:123], a[8:11], v[148:151]
    s_waitcnt lgkmcnt(3)
    v_mfma_f32_16x16x32_bf16 v[136:139], a[76:79], a[12:15], v[136:139]
    s_waitcnt lgkmcnt(2)
    v_mfma_f32_16x16x32_bf16 v[140:143], a[92:95], a[12:15], v[140:143]
    s_waitcnt lgkmcnt(1)
    v_mfma_f32_16x16x32_bf16 v[144:147], a[108:111], a[12:15], v[144:147]
    s_waitcnt lgkmcnt(0)
    v_mfma_f32_16x16x32_bf16 v[148:151], a[124:127], a[12:15], v[148:151]
    s_nop 1
    v_max3_f32 v248, v136, v137, v138
    s_nop 0
    v_max3_f32 v249, v140, v141, v142
    v_max3_f32 v248, v248, v139, v143
    v_max_f32 v248, v248, v249
    v_mov_b32 v249, v248
    s_nop 1
    v_permlane32_swap_b32 v248, v249
    v_max_f32 v248, v248, v249
    v_mov_b32 v249, v248
    s_nop 1
    v_permlane16_swap_b32 v248, v249
    v_max_f32 v248, v248, v249
    v_sub_f32 v200, 0, v248
    v_sub_f32 v201, 0, v248
    v_sub_f32 v202, 0, v248
    v_sub_f32 v203, 0, v248
    v_add_f32 v136, v136, v200
    v_add_f32 v137, v137, v200
    v_add_f32 v138, v138, v200
    v_add_f32 v139, v139, v200
    v_add_f32 v140, v140, v200
    v_add_f32 v141, v141, v200
    v_add_f32 v142, v142, v200
    v_add_f32 v143, v143, v200
    v_add_f32 v144, v144, v200
    v_add_f32 v145, v145, v200
    v_add_f32 v146, v146, v200
    v_add_f32 v147, v147, v200
    v_add_f32 v148, v148, v200
    v_add_f32 v149, v149, v200
    v_add_f32 v150, v150, v200
    v_add_f32 v151, v151, v200
    v_exp_f32 v136, v136
    v_exp_f32 v137, v137
    v_exp_f32 v138, v138
    v_cvt_pk_bf16_f32 v136, v136, v137
    v_exp_f32 v139, v139
    v_exp_f32 v140, v140
    v_cvt_pk_bf16_f32 v137, v138, v139
    v_exp_f32 v141, v141
    v_exp_f32 v142, v142
    s_waitcnt vmcnt(1)
    s_barrier
    ds_read_b128 v[104:107], v244 offset:4096
    ds_read_b128 v[108:111], v245 offset:4096
    ds_read_b128 v[112:115], v246 offset:4096
    ds_read_b128 v[116:119], v247 offset:4096
    s_add_u32 m0, s33, 8192
    s_add_u32 s28, s84, 8192
    buffer_load_dwordx4 v228, s[4:7], s28 offen offset:0 lds
    v_cvt_pk_bf16_f32 v138, v140, v141
    v_exp_f32 v143, v143
    v_exp_f32 v144, v144
    v_cvt_pk_bf16_f32 v139, v142, v143
    v_exp_f32 v145, v145
    v_exp_f32 v146, v146
    v_cvt_pk_bf16_f32 v140, v144, v145
    v_exp_f32 v147, v147
    v_exp_f32 v148, v148
    v_cvt_pk_bf16_f32 v141, v146, v147
    v_exp_f32 v149, v149
    v_exp_f32 v150, v150
    v_cvt_pk_bf16_f32 v142, v148, v149
    v_exp_f32 v151, v151
    buffer_load_dwordx4 v229, s[4:7], s28 offen offset:1024 lds
    s_nop 0
    v_cvt_pk_bf16_f32 v143, v150, v151
    s_waitcnt lgkmcnt(3)
    v_lshlrev_b32 v120, 16, v104
    v_and_b32 v121, s30, v104
    v_lshlrev_b32 v122, 16, v105
    v_and_b32 v123, s30, v105
    v_lshlrev_b32 v124, 16, v106
    v_and_b32 v125, s30, v106
    v_lshlrev_b32 v126, 16, v107
    v_and_b32 v127, s30, v107
    v_pk_mul_f32 v[120:121], v[120:121], s[26:27]
    v_pk_mul_f32 v[122:123], v[122:123], s[26:27]
    v_pk_mul_f32 v[124:125], v[124:125], s[26:27]
    v_pk_mul_f32 v[126:127], v[126:127], s[26:27]
    buffer_load_dwordx4 v230, s[4:7], s28 offen offset:2048 lds
    v_cvt_pk_bf16_f32 v120, v120, v121
    v_cvt_pk_bf16_f32 v122, v122, v123
    v_cvt_pk_bf16_f32 v124, v124, v125
    v_cvt_pk_bf16_f32 v126, v126, v127
    v_accvgpr_write_b32 a16, v120
    v_accvgpr_write_b32 a17, v122
    v_accvgpr_write_b32 a18, v124
    v_accvgpr_write_b32 a19, v126
    s_waitcnt lgkmcnt(0)
    v_lshlrev_b32 v128, 16, v108
    v_and_b32 v129, s30, v108
    v_lshlrev_b32 v130, 16, v109
    v_and_b32 v131, s30, v109
    v_lshlrev_b32 v132, 16, v110
    v_and_b32 v133, s30, v110
    buffer_load_dwordx4 v231, s[4:7], s28 offen offset:3072 lds
    v_lshlrev_b32 v134, 16, v111
    v_and_b32 v135, s30, v111
    v_pk_mul_f32 v[128:129], v[128:129], s[26:27]
    v_pk_mul_f32 v[130:131], v[130:131], s[26:27]
    v_pk_mul_f32 v[132:133], v[132:133], s[26:27]
    v_pk_mul_f32 v[134:135], v[134:135], s[26:27]
    v_mfma_f32_16x16x32_bf16 v[152:155], a[64:67], a[16:19], 0
    ds_read_b64_tr_b16 a[128:129], v220 offset:16384
    ds_read_b64_tr_b16 a[130:131], v220 offset:20480
    v_cvt_pk_bf16_f32 v128, v128, v129
    v_cvt_pk_bf16_f32 v130, v130, v131
    v_mfma_f32_16x16x32_bf16 v[156:159], a[80:83], a[16:19], 0
    ds_read_b64_tr_b16 a[160:161], v220 offset:24576
    ds_read_b64_tr_b16 a[162:163], v220 offset:28672
    v_cvt_pk_bf16_f32 v132, v132, v133
    v_cvt_pk_bf16_f32 v134, v134, v135
    v_mfma_f32_16x16x32_bf16 v[160:163], a[96:99], a[16:19], 0
    ds_read_b64_tr_b16 a[132:133], v221 offset:16384
    ds_read_b64_tr_b16 a[134:135], v221 offset:20480
    v_accvgpr_write_b32 a20, v128
    v_accvgpr_write_b32 a21, v130
    v_mfma_f32_16x16x32_bf16 v[164:167], a[112:115], a[16:19], 0
    ds_read_b64_tr_b16 a[164:165], v221 offset:24576
    ds_read_b64_tr_b16 a[166:167], v221 offset:28672
    v_accvgpr_write_b32 a22, v132
    v_accvgpr_write_b32 a23, v134
    v_lshlrev_b32 v120, 16, v112
    v_and_b32 v121, s30, v112
    v_lshlrev_b32 v122, 16, v113
    v_and_b32 v123, s30, v113
    v_lshlrev_b32 v124, 16, v114
    v_and_b32 v125, s30, v114
    v_lshlrev_b32 v126, 16, v115
    v_and_b32 v127, s30, v115
    v_pk_mul_f32 v[120:121], v[120:121], s[26:27]
    v_pk_mul_f32 v[122:123], v[122:123], s[26:27]
    v_pk_mul_f32 v[124:125], v[124:125], s[26:27]
    v_pk_mul_f32 v[126:127], v[126:127], s[26:27]
    v_mfma_f32_16x16x32_bf16 v[152:155], a[68:71], a[20:23], v[152:155]
    ds_read_b64_tr_b16 a[136:137], v222 offset:16384
    ds_read_b64_tr_b16 a[138:139], v222 offset:20480
    v_cvt_pk_bf16_f32 v120, v120, v121
    v_cvt_pk_bf16_f32 v122, v122, v123
    v_mfma_f32_16x16x32_bf16 v[156:159], a[84:87], a[20:23], v[156:159]
    ds_read_b64_tr_b16 a[168:169], v222 offset:24576
    ds_read_b64_tr_b16 a[170:171], v222 offset:28672
    v_cvt_pk_bf16_f32 v124, v124, v125
    v_cvt_pk_bf16_f32 v126, v126, v127
    v_mfma_f32_16x16x32_bf16 v[160:163], a[100:103], a[20:23], v[160:163]
    ds_read_b64_tr_b16 a[140:141], v223 offset:16384
    ds_read_b64_tr_b16 a[142:143], v223 offset:20480
    v_accvgpr_write_b32 a24, v120
    v_accvgpr_write_b32 a25, v122
    v_mfma_f32_16x16x32_bf16 v[164:167], a[116:119], a[20:23], v[164:167]
    ds_read_b64_tr_b16 a[172:173], v223 offset:24576
    ds_read_b64_tr_b16 a[174:175], v223 offset:28672
    v_accvgpr_write_b32 a26, v124
    v_accvgpr_write_b32 a27, v126
    v_lshlrev_b32 v128, 16, v116
    v_and_b32 v129, s30, v116
    v_lshlrev_b32 v130, 16, v117
    v_and_b32 v131, s30, v117
    v_lshlrev_b32 v132, 16, v118
    v_and_b32 v133, s30, v118
    v_lshlrev_b32 v134, 16, v119
    v_and_b32 v135, s30, v119
    v_pk_mul_f32 v[128:129], v[128:129], s[26:27]
    v_pk_mul_f32 v[130:131], v[130:131], s[26:27]
    v_pk_mul_f32 v[132:133], v[132:133], s[26:27]
    v_pk_mul_f32 v[134:135], v[134:135], s[26:27]
    v_mfma_f32_16x16x32_bf16 v[152:155], a[72:75], a[24:27], v[152:155]
    ds_read_b64_tr_b16 a[144:145], v224 offset:16384
    ds_read_b64_tr_b16 a[146:147], v224 offset:20480
    v_cvt_pk_bf16_f32 v128, v128, v129
    v_cvt_pk_bf16_f32 v130, v130, v131
    v_mfma_f32_16x16x32_bf16 v[156:159], a[88:91], a[24:27], v[156:159]
    ds_read_b64_tr_b16 a[176:177], v224 offset:24576
    ds_read_b64_tr_b16 a[178:179], v224 offset:28672
    v_cvt_pk_bf16_f32 v132, v132, v133
    v_cvt_pk_bf16_f32 v134, v134, v135
    v_mfma_f32_16x16x32_bf16 v[160:163], a[104:107], a[24:27], v[160:163]
    ds_read_b64_tr_b16 a[148:149], v225 offset:16384
    ds_read_b64_tr_b16 a[150:151], v225 offset:20480
    v_accvgpr_write_b32 a28, v128
    v_accvgpr_write_b32 a29, v130
    v_mfma_f32_16x16x32_bf16 v[164:167], a[120:123], a[24:27], v[164:167]
    ds_read_b64_tr_b16 a[180:181], v225 offset:24576
    ds_read_b64_tr_b16 a[182:183], v225 offset:28672
    v_accvgpr_write_b32 a30, v132
    v_accvgpr_write_b32 a31, v134
    s_nop 0
    s_nop 0
    v_mfma_f32_16x16x32_bf16 v[152:155], a[76:79], a[28:31], v[152:155]
    ds_read_b64_tr_b16 a[152:153], v226 offset:16384
    ds_read_b64_tr_b16 a[154:155], v226 offset:20480
    v_mfma_f32_16x16x32_bf16 v[156:159], a[92:95], a[28:31], v[156:159]
    ds_read_b64_tr_b16 a[184:185], v226 offset:24576
    ds_read_b64_tr_b16 a[186:187], v226 offset:28672
    v_mfma_f32_16x16x32_bf16 v[160:163], a[108:111], a[28:31], v[160:163]
    ds_read_b64_tr_b16 a[156:157], v227 offset:16384
    ds_read_b64_tr_b16 a[158:159], v227 offset:20480
    v_mfma_f32_16x16x32_bf16 v[164:167], a[124:127], a[28:31], v[164:167]
    ds_read_b64_tr_b16 a[188:189], v227 offset:24576
    ds_read_b64_tr_b16 a[190:191], v227 offset:28672
    v_smfmac_f32_16x16x64_bf16 a[192:195], a[208:211], v[136:143], v168
    s_waitcnt lgkmcnt(12)
    v_mfma_f32_16x16x32_bf16 v[8:11], a[128:131], v[136:139], 0
    v_mfma_f32_16x16x32_bf16 v[8:11], a[160:163], v[140:143], v[8:11]
    v_max3_f32 v250, v152, v153, v154
    v_max3_f32 v251, v156, v157, v158
    v_max3_f32 v250, v250, v155, v159
    v_max_f32 v250, v250, v251
    v_mfma_f32_16x16x32_bf16 v[12:15], a[132:135], v[136:139], 0
    v_mov_b32 v251, v250
    s_nop 1
    v_mfma_f32_16x16x32_bf16 v[12:15], a[164:167], v[140:143], v[12:15]
    v_permlane32_swap_b32 v250, v251
    v_max_f32 v250, v250, v251
    v_mov_b32 v251, v250
    v_mfma_f32_16x16x32_bf16 v[16:19], a[136:139], v[136:139], 0
    s_nop 1
    v_permlane16_swap_b32 v250, v251
    v_mfma_f32_16x16x32_bf16 v[16:19], a[168:171], v[140:143], v[16:19]
    v_max_f32 v250, v250, v251
    v_sub_f32 v204, 0, v250
    v_sub_f32 v205, 0, v250
    v_sub_f32 v206, 0, v250
    v_mfma_f32_16x16x32_bf16 v[20:23], a[140:143], v[136:139], 0
    v_sub_f32 v207, 0, v250
    v_add_f32 v152, v152, v204
    v_add_f32 v153, v153, v204
    v_add_f32 v154, v154, v204
    v_mfma_f32_16x16x32_bf16 v[20:23], a[172:175], v[140:143], v[20:23]
    v_add_f32 v155, v155, v204
    v_add_f32 v156, v156, v204
    v_add_f32 v157, v157, v204
    v_add_f32 v158, v158, v204
    v_mfma_f32_16x16x32_bf16 v[24:27], a[144:147], v[136:139], 0
    v_add_f32 v159, v159, v204
    v_add_f32 v160, v160, v204
    v_add_f32 v161, v161, v204
    v_add_f32 v162, v162, v204
    v_mfma_f32_16x16x32_bf16 v[24:27], a[176:179], v[140:143], v[24:27]
    s_waitcnt lgkmcnt(0)
    v_add_f32 v163, v163, v204
    v_add_f32 v164, v164, v204
    v_add_f32 v165, v165, v204
    v_add_f32 v166, v166, v204
    v_mfma_f32_16x16x32_bf16 v[28:31], a[148:151], v[136:139], 0
    v_add_f32 v167, v167, v204
    v_exp_f32 v152, v152
    v_mfma_f32_16x16x32_bf16 v[28:31], a[180:183], v[140:143], v[28:31]
    v_exp_f32 v153, v153
    v_exp_f32 v154, v154
    v_mfma_f32_16x16x32_bf16 v[32:35], a[152:155], v[136:139], 0
    v_cvt_pk_bf16_f32 v152, v152, v153
    v_exp_f32 v155, v155
    v_mfma_f32_16x16x32_bf16 v[32:35], a[184:187], v[140:143], v[32:35]
    v_exp_f32 v156, v156
    v_cvt_pk_bf16_f32 v153, v154, v155
    v_mfma_f32_16x16x32_bf16 v[36:39], a[156:159], v[136:139], 0
    v_exp_f32 v157, v157
    v_exp_f32 v158, v158
    v_mfma_f32_16x16x32_bf16 v[36:39], a[188:191], v[140:143], v[36:39]
    s_waitcnt vmcnt(0)
    ds_read_b128 v[104:107], v244 offset:8192
    ds_read_b128 v[108:111], v245 offset:8192
    ds_read_b128 v[112:115], v246 offset:8192
    ds_read_b128 v[116:119], v247 offset:8192
    s_add_u32 m0, s33, 12288
    s_add_u32 s28, s84, 12288
    buffer_load_dwordx4 v228, s[4:7], s28 offen offset:0 lds
    v_cvt_pk_bf16_f32 v154, v156, v157
    v_exp_f32 v159, v159
    v_exp_f32 v160, v160
    v_cvt_pk_bf16_f32 v155, v158, v159
    v_exp_f32 v161, v161
    v_exp_f32 v162, v162
    v_cvt_pk_bf16_f32 v156, v160, v161
    v_exp_f32 v163, v163
    v_exp_f32 v164, v164
    v_cvt_pk_bf16_f32 v157, v162, v163
    v_exp_f32 v165, v165
    v_exp_f32 v166, v166
    v_cvt_pk_bf16_f32 v158, v164, v165
    v_exp_f32 v167, v167
    buffer_load_dwordx4 v229, s[4:7], s28 offen offset:1024 lds
    s_nop 0
    v_cvt_pk_bf16_f32 v159, v166, v167
    s_waitcnt lgkmcnt(3)
    v_lshlrev_b32 v120, 16, v104
    v_and_b32 v121, s30, v104
    v_lshlrev_b32 v122, 16, v105
    v_and_b32 v123, s30, v105
    v_lshlrev_b32 v124, 16, v106
    v_and_b32 v125, s30, v106
    v_lshlrev_b32 v126, 16, v107
    v_and_b32 v127, s30, v107
    v_pk_mul_f32 v[120:121], v[120:121], s[26:27]
    v_pk_mul_f32 v[122:123], v[122:123], s[26:27]
    v_pk_mul_f32 v[124:125], v[124:125], s[26:27]
    v_pk_mul_f32 v[126:127], v[126:127], s[26:27]
    buffer_load_dwordx4 v230, s[4:7], s28 offen offset:2048 lds
    v_cvt_pk_bf16_f32 v120, v120, v121
    v_cvt_pk_bf16_f32 v122, v122, v123
    v_cvt_pk_bf16_f32 v124, v124, v125
    v_cvt_pk_bf16_f32 v126, v126, v127
    v_accvgpr_write_b32 a32, v120
    v_accvgpr_write_b32 a33, v122
    v_accvgpr_write_b32 a34, v124
    v_accvgpr_write_b32 a35, v126
    s_waitcnt lgkmcnt(0)
    v_lshlrev_b32 v128, 16, v108
    v_and_b32 v129, s30, v108
    v_lshlrev_b32 v130, 16, v109
    v_and_b32 v131, s30, v109
    v_lshlrev_b32 v132, 16, v110
    v_and_b32 v133, s30, v110
    buffer_load_dwordx4 v231, s[4:7], s28 offen offset:3072 lds
    v_lshlrev_b32 v134, 16, v111
    v_and_b32 v135, s30, v111
    v_pk_mul_f32 v[128:129], v[128:129], s[26:27]
    v_pk_mul_f32 v[130:131], v[130:131], s[26:27]
    v_pk_mul_f32 v[132:133], v[132:133], s[26:27]
    v_pk_mul_f32 v[134:135], v[134:135], s[26:27]
    v_mfma_f32_16x16x32_bf16 v[136:139], a[64:67], a[32:35], 0
    v_cvt_pk_bf16_f32 v128, v128, v129
    v_cvt_pk_bf16_f32 v130, v130, v131
    v_mfma_f32_16x16x32_bf16 v[140:143], a[80:83], a[32:35], 0
    v_cvt_pk_bf16_f32 v132, v132, v133
    v_cvt_pk_bf16_f32 v134, v134, v135
    v_mfma_f32_16x16x32_bf16 v[144:147], a[96:99], a[32:35], 0
    v_accvgpr_write_b32 a36, v128
    s_mov_b32 s23, 16384
    s_add_u32 m0, s21, 16384
    s_nop 0
    buffer_load_dwordx4 v228, s[8:11], s23 offen offset:0 lds
    v_accvgpr_write_b32 a37, v130
    v_mfma_f32_16x16x32_bf16 v[148:151], a[112:115], a[32:35], 0
    v_accvgpr_write_b32 a38, v132
    v_accvgpr_write_b32 a39, v134
    v_lshlrev_b32 v120, 16, v112
    v_and_b32 v121, s30, v112
    v_lshlrev_b32 v122, 16, v113
    v_and_b32 v123, s30, v113
    v_lshlrev_b32 v124, 16, v114
    v_and_b32 v125, s30, v114
    v_lshlrev_b32 v126, 16, v115
    v_and_b32 v127, s30, v115
    v_pk_mul_f32 v[120:121], v[120:121], s[26:27]
    v_pk_mul_f32 v[122:123], v[122:123], s[26:27]
    buffer_load_dwordx4 v229, s[8:11], s23 offen offset:1024 lds
    v_pk_mul_f32 v[124:125], v[124:125], s[26:27]
    v_pk_mul_f32 v[126:127], v[126:127], s[26:27]
    v_mfma_f32_16x16x32_bf16 v[136:139], a[68:71], a[36:39], v[136:139]
    v_cvt_pk_bf16_f32 v120, v120, v121
    v_cvt_pk_bf16_f32 v122, v122, v123
    v_mfma_f32_16x16x32_bf16 v[140:143], a[84:87], a[36:39], v[140:143]
    v_cvt_pk_bf16_f32 v124, v124, v125
    v_cvt_pk_bf16_f32 v126, v126, v127
    v_mfma_f32_16x16x32_bf16 v[144:147], a[100:103], a[36:39], v[144:147]
    v_accvgpr_write_b32 a40, v120
    v_accvgpr_write_b32 a41, v122
    v_mfma_f32_16x16x32_bf16 v[148:151], a[116:119], a[36:39], v[148:151]
    v_accvgpr_write_b32 a42, v124
    v_accvgpr_write_b32 a43, v126
    buffer_load_dwordx4 v230, s[8:11], s23 offen offset:2048 lds
    v_lshlrev_b32 v128, 16, v116
    v_and_b32 v129, s30, v116
    v_lshlrev_b32 v130, 16, v117
    v_and_b32 v131, s30, v117
    v_lshlrev_b32 v132, 16, v118
    v_and_b32 v133, s30, v118
    v_lshlrev_b32 v134, 16, v119
    v_and_b32 v135, s30, v119
    v_pk_mul_f32 v[128:129], v[128:129], s[26:27]
    v_pk_mul_f32 v[130:131], v[130:131], s[26:27]
    v_pk_mul_f32 v[132:133], v[132:133], s[26:27]
    v_pk_mul_f32 v[134:135], v[134:135], s[26:27]
    v_mfma_f32_16x16x32_bf16 v[136:139], a[72:75], a[40:43], v[136:139]
    v_cvt_pk_bf16_f32 v128, v128, v129
    buffer_load_dwordx4 v231, s[8:11], s23 offen offset:3072 lds
    v_cvt_pk_bf16_f32 v130, v130, v131
    v_mfma_f32_16x16x32_bf16 v[140:143], a[88:91], a[40:43], v[140:143]
    v_cvt_pk_bf16_f32 v132, v132, v133
    v_cvt_pk_bf16_f32 v134, v134, v135
    v_mfma_f32_16x16x32_bf16 v[144:147], a[104:107], a[40:43], v[144:147]
    v_accvgpr_write_b32 a44, v128
    v_accvgpr_write_b32 a45, v130
    v_mfma_f32_16x16x32_bf16 v[148:151], a[120:123], a[40:43], v[148:151]
    v_accvgpr_write_b32 a46, v132
    v_accvgpr_write_b32 a47, v134
    s_nop 0
    s_nop 0
    v_mfma_f32_16x16x32_bf16 v[136:139], a[76:79], a[44:47], v[136:139]
    v_mfma_f32_16x16x32_bf16 v[140:143], a[92:95], a[44:47], v[140:143]
    v_mfma_f32_16x16x32_bf16 v[144:147], a[108:111], a[44:47], v[144:147]
    v_mfma_f32_16x16x32_bf16 v[148:151], a[124:127], a[44:47], v[148:151]
    v_smfmac_f32_16x16x64_bf16 a[196:199], a[208:211], v[152:159], v168
    v_mfma_f32_16x16x32_bf16 v[40:43], a[128:131], v[152:155], 0
    v_mfma_f32_16x16x32_bf16 v[40:43], a[160:163], v[156:159], v[40:43]
    s_nop 1
    v_max3_f32 v248, v136, v137, v138
    v_max3_f32 v249, v140, v141, v142
    v_max3_f32 v248, v248, v139, v143
    v_max_f32 v248, v248, v249
    v_mfma_f32_16x16x32_bf16 v[44:47], a[132:135], v[152:155], 0
    v_mov_b32 v249, v248
    s_nop 1
    v_mfma_f32_16x16x32_bf16 v[44:47], a[164:167], v[156:159], v[44:47]
    v_permlane32_swap_b32 v248, v249
    v_max_f32 v248, v248, v249
    v_mov_b32 v249, v248
    v_mfma_f32_16x16x32_bf16 v[48:51], a[136:139], v[152:155], 0
    s_nop 1
    v_permlane16_swap_b32 v248, v249
    v_mfma_f32_16x16x32_bf16 v[48:51], a[168:171], v[156:159], v[48:51]
    v_max_f32 v248, v248, v249
    v_sub_f32 v208, 0, v248
    v_sub_f32 v209, 0, v248
    v_sub_f32 v210, 0, v248
    v_mfma_f32_16x16x32_bf16 v[52:55], a[140:143], v[152:155], 0
    v_sub_f32 v211, 0, v248
    v_add_f32 v136, v136, v208
    v_add_f32 v137, v137, v208
    v_add_f32 v138, v138, v208
    v_mfma_f32_16x16x32_bf16 v[52:55], a[172:175], v[156:159], v[52:55]
    v_add_f32 v139, v139, v208
    v_add_f32 v140, v140, v208
    v_add_f32 v141, v141, v208
    v_add_f32 v142, v142, v208
    v_mfma_f32_16x16x32_bf16 v[56:59], a[144:147], v[152:155], 0
    v_add_f32 v143, v143, v208
    v_add_f32 v144, v144, v208
    v_add_f32 v145, v145, v208
    v_add_f32 v146, v146, v208
    v_mfma_f32_16x16x32_bf16 v[56:59], a[176:179], v[156:159], v[56:59]
    v_add_f32 v147, v147, v208
    v_add_f32 v148, v148, v208
    v_add_f32 v149, v149, v208
    v_add_f32 v150, v150, v208
    v_mfma_f32_16x16x32_bf16 v[60:63], a[148:151], v[152:155], 0
    v_add_f32 v151, v151, v208
    v_exp_f32 v136, v136
    v_mfma_f32_16x16x32_bf16 v[60:63], a[180:183], v[156:159], v[60:63]
    v_exp_f32 v137, v137
    v_exp_f32 v138, v138
    v_mfma_f32_16x16x32_bf16 v[64:67], a[152:155], v[152:155], 0
    v_cvt_pk_bf16_f32 v136, v136, v137
    v_exp_f32 v139, v139
    v_mfma_f32_16x16x32_bf16 v[64:67], a[184:187], v[156:159], v[64:67]
    v_exp_f32 v140, v140
    v_cvt_pk_bf16_f32 v137, v138, v139
    v_mfma_f32_16x16x32_bf16 v[68:71], a[156:159], v[152:155], 0
    v_exp_f32 v141, v141
    v_exp_f32 v142, v142
    v_mfma_f32_16x16x32_bf16 v[68:71], a[188:191], v[156:159], v[68:71]
    s_waitcnt vmcnt(4)
    ds_read_b128 v[104:107], v244 offset:12288
    ds_read_b128 v[108:111], v245 offset:12288
    ds_read_b128 v[112:115], v246 offset:12288
    ds_read_b128 v[116:119], v247 offset:12288
    s_mov_b32 s24, 16384
    s_add_u32 m0, s22, 32768
    s_nop 0
    buffer_load_dwordx4 v232, s[12:15], s24 offen offset:0 lds
    v_cvt_pk_bf16_f32 v138, v140, v141
    v_exp_f32 v143, v143
    v_exp_f32 v144, v144
    v_cvt_pk_bf16_f32 v139, v142, v143
    v_exp_f32 v145, v145
    v_exp_f32 v146, v146
    v_cvt_pk_bf16_f32 v140, v144, v145
    v_exp_f32 v147, v147
    v_exp_f32 v148, v148
    v_cvt_pk_bf16_f32 v141, v146, v147
    v_exp_f32 v149, v149
    v_exp_f32 v150, v150
    v_cvt_pk_bf16_f32 v142, v148, v149
    v_exp_f32 v151, v151
    buffer_load_dwordx4 v233, s[12:15], s24 offen offset:1024 lds
    s_nop 0
    v_cvt_pk_bf16_f32 v143, v150, v151
    s_waitcnt lgkmcnt(2)
    v_lshlrev_b32 v120, 16, v104
    v_and_b32 v121, s30, v104
    v_lshlrev_b32 v122, 16, v105
    v_and_b32 v123, s30, v105
    v_lshlrev_b32 v124, 16, v106
    v_and_b32 v125, s30, v106
    v_lshlrev_b32 v126, 16, v107
    v_and_b32 v127, s30, v107
    v_pk_mul_f32 v[120:121], v[120:121], s[26:27]
    v_pk_mul_f32 v[122:123], v[122:123], s[26:27]
    v_pk_mul_f32 v[124:125], v[124:125], s[26:27]
    v_pk_mul_f32 v[126:127], v[126:127], s[26:27]
    buffer_load_dwordx4 v232, s[12:15], s24 offen offset:2048 lds
    v_cvt_pk_bf16_f32 v120, v120, v121
    v_cvt_pk_bf16_f32 v122, v122, v123
    v_cvt_pk_bf16_f32 v124, v124, v125
    v_cvt_pk_bf16_f32 v126, v126, v127
    v_accvgpr_write_b32 a48, v120
    v_accvgpr_write_b32 a49, v122
    v_accvgpr_write_b32 a50, v124
    v_accvgpr_write_b32 a51, v126
    v_lshlrev_b32 v128, 16, v108
    v_and_b32 v129, s30, v108
    v_lshlrev_b32 v130, 16, v109
    v_and_b32 v131, s30, v109
    v_lshlrev_b32 v132, 16, v110
    v_and_b32 v133, s30, v110
    buffer_load_dwordx4 v233, s[12:15], s24 offen offset:3072 lds
    v_lshlrev_b32 v134, 16, v111
    v_and_b32 v135, s30, v111
    v_pk_mul_f32 v[128:129], v[128:129], s[26:27]
    v_pk_mul_f32 v[130:131], v[130:131], s[26:27]
    v_pk_mul_f32 v[132:133], v[132:133], s[26:27]
    v_pk_mul_f32 v[134:135], v[134:135], s[26:27]
    v_mfma_f32_16x16x32_bf16 v[152:155], a[64:67], a[48:51], 0
    v_cvt_pk_bf16_f32 v128, v128, v129
    v_cvt_pk_bf16_f32 v130, v130, v131
    v_mfma_f32_16x16x32_bf16 v[156:159], a[80:83], a[48:51], 0
    v_cvt_pk_bf16_f32 v132, v132, v133
    v_cvt_pk_bf16_f32 v134, v134, v135
    v_mfma_f32_16x16x32_bf16 v[160:163], a[96:99], a[48:51], 0
    v_accvgpr_write_b32 a52, v128
    v_accvgpr_write_b32 a53, v130
    v_mfma_f32_16x16x32_bf16 v[164:167], a[112:115], a[48:51], 0
    v_accvgpr_write_b32 a54, v132
    v_accvgpr_write_b32 a55, v134
    s_waitcnt lgkmcnt(0)
    v_lshlrev_b32 v120, 16, v112
    v_and_b32 v121, s30, v112
    v_lshlrev_b32 v122, 16, v113
    v_and_b32 v123, s30, v113
    v_lshlrev_b32 v124, 16, v114
    v_and_b32 v125, s30, v114
    v_lshlrev_b32 v126, 16, v115
    v_and_b32 v127, s30, v115
    v_pk_mul_f32 v[120:121], v[120:121], s[26:27]
    v_pk_mul_f32 v[122:123], v[122:123], s[26:27]
    v_pk_mul_f32 v[124:125], v[124:125], s[26:27]
    v_pk_mul_f32 v[126:127], v[126:127], s[26:27]
    v_mfma_f32_16x16x32_bf16 v[152:155], a[68:71], a[52:55], v[152:155]
    v_cvt_pk_bf16_f32 v120, v120, v121
    v_cvt_pk_bf16_f32 v122, v122, v123
    v_mfma_f32_16x16x32_bf16 v[156:159], a[84:87], a[52:55], v[156:159]
    v_cvt_pk_bf16_f32 v124, v124, v125
    v_cvt_pk_bf16_f32 v126, v126, v127
    v_mfma_f32_16x16x32_bf16 v[160:163], a[100:103], a[52:55], v[160:163]
    v_accvgpr_write_b32 a56, v120
    v_accvgpr_write_b32 a57, v122
    v_mfma_f32_16x16x32_bf16 v[164:167], a[116:119], a[52:55], v[164:167]
    v_accvgpr_write_b32 a58, v124
    v_accvgpr_write_b32 a59, v126
    v_lshlrev_b32 v128, 16, v116
    v_and_b32 v129, s30, v116
    v_lshlrev_b32 v130, 16, v117
    v_and_b32 v131, s30, v117
    v_lshlrev_b32 v132, 16, v118
    v_and_b32 v133, s30, v118
    v_lshlrev_b32 v134, 16, v119
    v_and_b32 v135, s30, v119
    v_pk_mul_f32 v[128:129], v[128:129], s[26:27]
    v_pk_mul_f32 v[130:131], v[130:131], s[26:27]
    v_pk_mul_f32 v[132:133], v[132:133], s[26:27]
    v_pk_mul_f32 v[134:135], v[134:135], s[26:27]
    v_mfma_f32_16x16x32_bf16 v[152:155], a[72:75], a[56:59], v[152:155]
    v_cvt_pk_bf16_f32 v128, v128, v129
    v_cvt_pk_bf16_f32 v130, v130, v131
    v_mfma_f32_16x16x32_bf16 v[156:159], a[88:91], a[56:59], v[156:159]
    v_cvt_pk_bf16_f32 v132, v132, v133
    v_cvt_pk_bf16_f32 v134, v134, v135
    v_mfma_f32_16x16x32_bf16 v[160:163], a[104:107], a[56:59], v[160:163]
    v_accvgpr_write_b32 a60, v128
    v_accvgpr_write_b32 a61, v130
    v_mfma_f32_16x16x32_bf16 v[164:167], a[120:123], a[56:59], v[164:167]
    v_accvgpr_write_b32 a62, v132
    v_accvgpr_write_b32 a63, v134
    s_nop 0
    s_nop 0
    v_mfma_f32_16x16x32_bf16 v[152:155], a[76:79], a[60:63], v[152:155]
    v_mfma_f32_16x16x32_bf16 v[156:159], a[92:95], a[60:63], v[156:159]
    v_mfma_f32_16x16x32_bf16 v[160:163], a[108:111], a[60:63], v[160:163]
    v_mfma_f32_16x16x32_bf16 v[164:167], a[124:127], a[60:63], v[164:167]
    s_waitcnt vmcnt(4)
    s_barrier
    v_smfmac_f32_16x16x64_bf16 a[200:203], a[208:211], v[136:143], v168
    ds_read_b128 a[64:67], v216 offset:16384
    ds_read_b128 a[68:71], v217 offset:16384
    v_mfma_f32_16x16x32_bf16 v[72:75], a[128:131], v[136:139], 0
    ds_read_b128 a[72:75], v218 offset:16384
    ds_read_b128 a[76:79], v219 offset:16384
    v_max3_f32 v250, v152, v153, v154
    v_max3_f32 v251, v156, v157, v158
    v_mfma_f32_16x16x32_bf16 v[72:75], a[160:163], v[140:143], v[72:75]
    ds_read_b128 a[92:95], v219 offset:20480
    ds_read_b128 a[88:91], v218 offset:20480
    v_max3_f32 v250, v250, v155, v159
    v_max_f32 v250, v250, v251
    v_mfma_f32_16x16x32_bf16 v[76:79], a[132:135], v[136:139], 0
    s_mov_b32 s23, 32768
    s_add_u32 m0, s21, 32768
    s_nop 0
    buffer_load_dwordx4 v228, s[8:11], s23 offen offset:0 lds
    ds_read_b128 a[84:87], v217 offset:20480
    ds_read_b128 a[80:83], v216 offset:20480
    v_mov_b32 v251, v250
    v_mfma_f32_16x16x32_bf16 v[76:79], a[164:167], v[140:143], v[76:79]
    ds_read_b128 a[96:99], v216 offset:24576
    ds_read_b128 a[100:103], v217 offset:24576
    s_nop 1
    v_mfma_f32_16x16x32_bf16 v[80:83], a[136:139], v[136:139], 0
    ds_read_b128 a[104:107], v218 offset:24576
    ds_read_b128 a[108:111], v219 offset:24576
    v_permlane32_swap_b32 v250, v251
    v_mfma_f32_16x16x32_bf16 v[80:83], a[168:171], v[140:143], v[80:83]
    ds_read_b128 a[124:127], v219 offset:28672
    buffer_load_dwordx4 v229, s[8:11], s23 offen offset:1024 lds
    ds_read_b128 a[120:123], v218 offset:28672
    v_max_f32 v250, v250, v251
    v_mov_b32 v251, v250
    v_mfma_f32_16x16x32_bf16 v[84:87], a[140:143], v[136:139], 0
    ds_read_b128 a[116:119], v217 offset:28672
    ds_read_b128 a[112:115], v216 offset:28672
    s_nop 1
    v_mfma_f32_16x16x32_bf16 v[84:87], a[172:175], v[140:143], v[84:87]
    v_permlane16_swap_b32 v250, v251
    v_max_f32 v250, v250, v251
    v_sub_f32 v212, 0, v250
    v_mfma_f32_16x16x32_bf16 v[88:91], a[144:147], v[136:139], 0
    v_sub_f32 v213, 0, v250
    buffer_load_dwordx4 v230, s[8:11], s23 offen offset:2048 lds
    v_sub_f32 v214, 0, v250
    v_sub_f32 v215, 0, v250
    v_add_f32 v152, v152, v212
    v_mfma_f32_16x16x32_bf16 v[88:91], a[176:179], v[140:143], v[88:91]
    v_add_f32 v153, v153, v212
    v_add_f32 v154, v154, v212
    v_add_f32 v155, v155, v212
    v_add_f32 v156, v156, v212
    v_mfma_f32_16x16x32_bf16 v[92:95], a[148:151], v[136:139], 0
    v_add_f32 v157, v157, v212
    v_add_f32 v158, v158, v212
    v_add_f32 v159, v159, v212
    v_add_f32 v160, v160, v212
    v_mfma_f32_16x16x32_bf16 v[92:95], a[180:183], v[140:143], v[92:95]
    buffer_load_dwordx4 v231, s[8:11], s23 offen offset:3072 lds
    v_add_f32 v161, v161, v212
    v_add_f32 v162, v162, v212
    v_add_f32 v163, v163, v212
    v_add_f32 v164, v164, v212
    v_mfma_f32_16x16x32_bf16 v[96:99], a[152:155], v[136:139], 0
    v_add_f32 v165, v165, v212
    v_add_f32 v166, v166, v212
    v_add_f32 v167, v167, v212
    v_mfma_f32_16x16x32_bf16 v[96:99], a[184:187], v[140:143], v[96:99]
    v_exp_f32 v152, v152
    v_exp_f32 v153, v153
    v_mfma_f32_16x16x32_bf16 v[100:103], a[156:159], v[136:139], 0
    v_exp_f32 v154, v154
    s_mov_b32 s24, 32768
    s_add_u32 m0, s22, 49152
    s_nop 0
    buffer_load_dwordx4 v232, s[12:15], s24 offen offset:0 lds
    v_cvt_pk_bf16_f32 v152, v152, v153
    v_mfma_f32_16x16x32_bf16 v[100:103], a[188:191], v[140:143], v[100:103]
    s_waitcnt lgkmcnt(0)
    v_exp_f32 v155, v155
    v_exp_f32 v156, v156
    v_mfma_f32_16x16x32_bf16 v[136:139], a[64:67], a[0:3], v[200:203]
    v_cvt_pk_bf16_f32 v153, v154, v155
    v_exp_f32 v157, v157
    v_mfma_f32_16x16x32_bf16 v[136:139], a[68:71], a[4:7], v[136:139]
    v_exp_f32 v158, v158
    v_cvt_pk_bf16_f32 v154, v156, v157
    v_mfma_f32_16x16x32_bf16 v[136:139], a[72:75], a[8:11], v[136:139]
    v_exp_f32 v159, v159
    v_exp_f32 v160, v160
    v_mfma_f32_16x16x32_bf16 v[136:139], a[76:79], a[12:15], v[136:139]
    buffer_load_dwordx4 v233, s[12:15], s24 offen offset:1024 lds
    v_cvt_pk_bf16_f32 v155, v158, v159
    v_exp_f32 v161, v161
    v_mfma_f32_16x16x32_bf16 v[140:143], a[92:95], a[12:15], v[200:203]
    v_exp_f32 v162, v162
    v_cvt_pk_bf16_f32 v156, v160, v161
    v_mfma_f32_16x16x32_bf16 v[140:143], a[88:91], a[8:11], v[140:143]
    v_exp_f32 v163, v163
    v_exp_f32 v164, v164
    v_mfma_f32_16x16x32_bf16 v[140:143], a[84:87], a[4:7], v[140:143]
    v_cvt_pk_bf16_f32 v157, v162, v163
    v_exp_f32 v165, v165
    v_mfma_f32_16x16x32_bf16 v[140:143], a[80:83], a[0:3], v[140:143]
    v_exp_f32 v166, v166
    buffer_load_dwordx4 v232, s[12:15], s24 offen offset:2048 lds
    v_cvt_pk_bf16_f32 v158, v164, v165
    v_mfma_f32_16x16x32_bf16 v[144:147], a[96:99], a[0:3], v[200:203]
    v_exp_f32 v167, v167
    s_nop 0
    v_cvt_pk_bf16_f32 v159, v166, v167
    v_mfma_f32_16x16x32_bf16 v[144:147], a[100:103], a[4:7], v[144:147]
    v_exp_f32 v136, v136
    v_exp_f32 v137, v137
    v_mfma_f32_16x16x32_bf16 v[144:147], a[104:107], a[8:11], v[144:147]
    v_exp_f32 v138, v138
    v_cvt_pk_bf16_f32 v136, v136, v137
    v_mfma_f32_16x16x32_bf16 v[144:147], a[108:111], a[12:15], v[144:147]
    v_exp_f32 v139, v139
    buffer_load_dwordx4 v233, s[12:15], s24 offen offset:3072 lds
    v_exp_f32 v140, v140
    v_mfma_f32_16x16x32_bf16 v[148:151], a[124:127], a[12:15], v[200:203]
    v_cvt_pk_bf16_f32 v137, v138, v139
    v_exp_f32 v141, v141
    v_mfma_f32_16x16x32_bf16 v[148:151], a[120:123], a[8:11], v[148:151]
    v_exp_f32 v142, v142
    v_cvt_pk_bf16_f32 v138, v140, v141
    v_mfma_f32_16x16x32_bf16 v[148:151], a[116:119], a[4:7], v[148:151]
    v_exp_f32 v143, v143
    v_exp_f32 v144, v144
    v_mfma_f32_16x16x32_bf16 v[148:151], a[112:115], a[0:3], v[148:151]
    v_cvt_pk_bf16_f32 v139, v142, v143
    v_exp_f32 v145, v145
    v_smfmac_f32_16x16x64_bf16 a[204:207], a[208:211], v[152:159], v168
    s_waitcnt vmcnt(8)
    s_barrier
    v_exp_f32 v146, v146
    v_cvt_pk_bf16_f32 v140, v144, v145
    v_mfma_f32_16x16x32_bf16 v[104:107], a[128:131], v[152:155], 0
    s_mov_b32 s23, 49152
    s_add_u32 m0, s21, 49152
    s_nop 0
    buffer_load_dwordx4 v228, s[8:11], s23 offen offset:0 lds
    v_exp_f32 v147, v147
    v_mfma_f32_16x16x32_bf16 v[104:107], a[160:163], v[156:159], v[104:107]
    ds_read_b64_tr_b16 a[128:129], v220 offset:32768
    ds_read_b64_tr_b16 a[130:131], v220 offset:36864
    v_exp_f32 v148, v148
    v_cvt_pk_bf16_f32 v141, v146, v147
    v_mfma_f32_16x16x32_bf16 v[108:111], a[132:135], v[152:155], 0
    v_mfma_f32_16x16x32_bf16 v[108:111], a[164:167], v[156:159], v[108:111]
    ds_read_b64_tr_b16 a[160:161], v220 offset:40960
    ds_read_b64_tr_b16 a[162:163], v220 offset:45056
    v_mfma_f32_16x16x32_bf16 v[112:115], a[136:139], v[152:155], 0
    v_mfma_f32_16x16x32_bf16 v[112:115], a[168:171], v[156:159], v[112:115]
    ds_read_b64_tr_b16 a[132:133], v221 offset:32768
    buffer_load_dwordx4 v229, s[8:11], s23 offen offset:1024 lds
    ds_read_b64_tr_b16 a[134:135], v221 offset:36864
    v_mfma_f32_16x16x32_bf16 v[116:119], a[140:143], v[152:155], 0
    v_mfma_f32_16x16x32_bf16 v[116:119], a[172:175], v[156:159], v[116:119]
    ds_read_b64_tr_b16 a[164:165], v221 offset:40960
    ds_read_b64_tr_b16 a[166:167], v221 offset:45056
    v_mfma_f32_16x16x32_bf16 v[120:123], a[144:147], v[152:155], 0
    v_mfma_f32_16x16x32_bf16 v[120:123], a[176:179], v[156:159], v[120:123]
    ds_read_b64_tr_b16 a[136:137], v222 offset:32768
    ds_read_b64_tr_b16 a[138:139], v222 offset:36864
    v_mfma_f32_16x16x32_bf16 v[124:127], a[148:151], v[152:155], 0
    v_mfma_f32_16x16x32_bf16 v[124:127], a[180:183], v[156:159], v[124:127]
    ds_read_b64_tr_b16 a[168:169], v222 offset:40960
    ds_read_b64_tr_b16 a[170:171], v222 offset:45056
    v_mfma_f32_16x16x32_bf16 v[128:131], a[152:155], v[152:155], 0
    buffer_load_dwordx4 v230, s[8:11], s23 offen offset:2048 lds
    v_mfma_f32_16x16x32_bf16 v[128:131], a[184:187], v[156:159], v[128:131]
    ds_read_b64_tr_b16 a[140:141], v223 offset:32768
    ds_read_b64_tr_b16 a[142:143], v223 offset:36864
    v_mfma_f32_16x16x32_bf16 v[132:135], a[156:159], v[152:155], 0
    v_mfma_f32_16x16x32_bf16 v[132:135], a[188:191], v[156:159], v[132:135]
    ds_read_b64_tr_b16 a[172:173], v223 offset:40960
    ds_read_b64_tr_b16 a[174:175], v223 offset:45056
    buffer_load_dwordx4 v231, s[8:11], s23 offen offset:3072 lds
    s_mov_b32 s23, 65536
    s_mov_b32 s24, 49152
    v_mfma_f32_16x16x32_bf16 v[152:155], a[64:67], a[16:19], v[204:207]
    ds_read_b64_tr_b16 a[144:145], v224 offset:32768
    ds_read_b64_tr_b16 a[146:147], v224 offset:36864
    v_mfma_f32_16x16x32_bf16 v[152:155], a[68:71], a[20:23], v[152:155]
    v_exp_f32 v149, v149
    v_mfma_f32_16x16x32_bf16 v[152:155], a[72:75], a[24:27], v[152:155]
    ds_read_b64_tr_b16 a[176:177], v224 offset:40960
    v_cvt_pk_bf16_f32 v142, v148, v149
    v_mfma_f32_16x16x32_bf16 v[152:155], a[76:79], a[28:31], v[152:155]
    v_exp_f32 v150, v150
    v_mfma_f32_16x16x32_bf16 v[156:159], a[92:95], a[28:31], v[204:207]
    ds_read_b64_tr_b16 a[178:179], v224 offset:45056
    ds_read_b64_tr_b16 a[148:149], v225 offset:32768
    s_nop 0
    v_mfma_f32_16x16x32_bf16 v[156:159], a[88:91], a[24:27], v[156:159]
    v_exp_f32 v151, v151
    v_mfma_f32_16x16x32_bf16 v[156:159], a[84:87], a[20:23], v[156:159]
    ds_read_b64_tr_b16 a[150:151], v225 offset:36864
    v_cvt_pk_bf16_f32 v143, v150, v151
    v_mfma_f32_16x16x32_bf16 v[156:159], a[80:83], a[16:19], v[156:159]
    v_exp_f32 v152, v152
    v_mfma_f32_16x16x32_bf16 v[160:163], a[96:99], a[16:19], v[204:207]
    ds_read_b64_tr_b16 a[180:181], v225 offset:40960
    ds_read_b64_tr_b16 a[182:183], v225 offset:45056
    v_mfma_f32_16x16x32_bf16 v[160:163], a[100:103], a[20:23], v[160:163]
    v_exp_f32 v153, v153
    v_mfma_f32_16x16x32_bf16 v[160:163], a[104:107], a[24:27], v[160:163]
    ds_read_b64_tr_b16 a[152:153], v226 offset:32768
    v_cvt_pk_bf16_f32 v152, v152, v153
    v_mfma_f32_16x16x32_bf16 v[160:163], a[108:111], a[28:31], v[160:163]
    v_exp_f32 v154, v154
    v_mfma_f32_16x16x32_bf16 v[164:167], a[124:127], a[28:31], v[204:207]
    ds_read_b64_tr_b16 a[154:155], v226 offset:36864
    ds_read_b64_tr_b16 a[184:185], v226 offset:40960
    v_mfma_f32_16x16x32_bf16 v[164:167], a[120:123], a[24:27], v[164:167]
    v_exp_f32 v155, v155
    v_mfma_f32_16x16x32_bf16 v[164:167], a[116:119], a[20:23], v[164:167]
    ds_read_b64_tr_b16 a[186:187], v226 offset:45056
    v_cvt_pk_bf16_f32 v153, v154, v155
    v_mfma_f32_16x16x32_bf16 v[164:167], a[112:115], a[16:19], v[164:167]
    v_exp_f32 v156, v156
    v_smfmac_f32_16x16x64_bf16 a[192:195], a[208:211], v[136:143], v168
    s_waitcnt lgkmcnt(6)
    ds_read_b64_tr_b16 a[156:157], v227 offset:32768
    ds_read_b64_tr_b16 a[158:159], v227 offset:36864
    v_mfma_f32_16x16x32_bf16 v[8:11], a[128:131], v[136:139], v[8:11]
    v_exp_f32 v157, v157
    v_mfma_f32_16x16x32_bf16 v[8:11], a[160:163], v[140:143], v[8:11]
    ds_read_b64_tr_b16 a[188:189], v227 offset:40960
    v_cvt_pk_bf16_f32 v154, v156, v157
    v_mfma_f32_16x16x32_bf16 v[12:15], a[132:135], v[136:139], v[12:15]
    v_exp_f32 v158, v158
    v_mfma_f32_16x16x32_bf16 v[12:15], a[164:167], v[140:143], v[12:15]
    ds_read_b64_tr_b16 a[190:191], v227 offset:45056
    v_mfma_f32_16x16x32_bf16 v[16:19], a[136:139], v[136:139], v[16:19]
    v_exp_f32 v159, v159
    v_mfma_f32_16x16x32_bf16 v[16:19], a[168:171], v[140:143], v[16:19]
    v_cvt_pk_bf16_f32 v155, v158, v159
    v_mfma_f32_16x16x32_bf16 v[20:23], a[140:143], v[136:139], v[20:23]
    v_exp_f32 v160, v160
    v_mfma_f32_16x16x32_bf16 v[20:23], a[172:175], v[140:143], v[20:23]
    v_mfma_f32_16x16x32_bf16 v[24:27], a[144:147], v[136:139], v[24:27]
    v_exp_f32 v161, v161
    v_mfma_f32_16x16x32_bf16 v[24:27], a[176:179], v[140:143], v[24:27]
    v_cvt_pk_bf16_f32 v156, v160, v161
    v_mfma_f32_16x16x32_bf16 v[28:31], a[148:151], v[136:139], v[28:31]
    s_waitcnt lgkmcnt(3)
    v_exp_f32 v162, v162
    v_mfma_f32_16x16x32_bf16 v[28:31], a[180:183], v[140:143], v[28:31]
    v_mfma_f32_16x16x32_bf16 v[32:35], a[152:155], v[136:139], v[32:35]
    v_exp_f32 v163, v163
    v_mfma_f32_16x16x32_bf16 v[32:35], a[184:187], v[140:143], v[32:35]
    s_waitcnt lgkmcnt(1)
    v_cvt_pk_bf16_f32 v157, v162, v163
    v_mfma_f32_16x16x32_bf16 v[36:39], a[156:159], v[136:139], v[36:39]
    s_waitcnt lgkmcnt(0)
    v_exp_f32 v164, v164
    v_mfma_f32_16x16x32_bf16 v[36:39], a[188:191], v[140:143], v[36:39]
    v_mfma_f32_16x16x32_bf16 v[136:139], a[64:67], a[32:35], v[208:211]
    v_mfma_f32_16x16x32_bf16 v[136:139], a[68:71], a[36:39], v[136:139]
    v_exp_f32 v165, v165
    v_mfma_f32_16x16x32_bf16 v[136:139], a[72:75], a[40:43], v[136:139]
    v_cvt_pk_bf16_f32 v158, v164, v165
    v_mfma_f32_16x16x32_bf16 v[136:139], a[76:79], a[44:47], v[136:139]
    v_exp_f32 v166, v166
    v_mfma_f32_16x16x32_bf16 v[140:143], a[92:95], a[44:47], v[208:211]
    s_nop 0
    v_mfma_f32_16x16x32_bf16 v[140:143], a[88:91], a[40:43], v[140:143]
    v_exp_f32 v167, v167
    v_mfma_f32_16x16x32_bf16 v[140:143], a[84:87], a[36:39], v[140:143]
    v_cvt_pk_bf16_f32 v159, v166, v167
    v_mfma_f32_16x16x32_bf16 v[140:143], a[80:83], a[32:35], v[140:143]
    s_add_u32 m0, s22, 0
    v_exp_f32 v136, v136
    v_mfma_f32_16x16x32_bf16 v[144:147], a[96:99], a[32:35], v[208:211]
    buffer_load_dwordx4 v232, s[12:15], s24 offen offset:0 lds
    v_mfma_f32_16x16x32_bf16 v[144:147], a[100:103], a[36:39], v[144:147]
    v_exp_f32 v137, v137
    v_mfma_f32_16x16x32_bf16 v[144:147], a[104:107], a[40:43], v[144:147]
    v_cvt_pk_bf16_f32 v136, v136, v137
    v_mfma_f32_16x16x32_bf16 v[144:147], a[108:111], a[44:47], v[144:147]
    v_exp_f32 v138, v138
    v_mfma_f32_16x16x32_bf16 v[148:151], a[124:127], a[44:47], v[208:211]
    buffer_load_dwordx4 v233, s[12:15], s24 offen offset:1024 lds
    v_mfma_f32_16x16x32_bf16 v[148:151], a[120:123], a[40:43], v[148:151]
    v_exp_f32 v139, v139
    v_mfma_f32_16x16x32_bf16 v[148:151], a[116:119], a[36:39], v[148:151]
    v_cvt_pk_bf16_f32 v137, v138, v139
    v_mfma_f32_16x16x32_bf16 v[148:151], a[112:115], a[32:35], v[148:151]
    v_exp_f32 v140, v140
    v_smfmac_f32_16x16x64_bf16 a[196:199], a[208:211], v[152:159], v168
    buffer_load_dwordx4 v232, s[12:15], s24 offen offset:2048 lds
    v_mfma_f32_16x16x32_bf16 v[40:43], a[128:131], v[152:155], v[40:43]
    v_exp_f32 v141, v141
    v_mfma_f32_16x16x32_bf16 v[40:43], a[160:163], v[156:159], v[40:43]
    v_cvt_pk_bf16_f32 v138, v140, v141
    v_mfma_f32_16x16x32_bf16 v[44:47], a[132:135], v[152:155], v[44:47]
    v_exp_f32 v142, v142
    v_mfma_f32_16x16x32_bf16 v[44:47], a[164:167], v[156:159], v[44:47]
    buffer_load_dwordx4 v233, s[12:15], s24 offen offset:3072 lds
    v_mfma_f32_16x16x32_bf16 v[48:51], a[136:139], v[152:155], v[48:51]
    s_add_u32 s24, s24, 16384
    v_exp_f32 v143, v143
    v_mfma_f32_16x16x32_bf16 v[48:51], a[168:171], v[156:159], v[48:51]
    v_cvt_pk_bf16_f32 v139, v142, v143
    v_mfma_f32_16x16x32_bf16 v[52:55], a[140:143], v[152:155], v[52:55]
    v_exp_f32 v144, v144
    v_mfma_f32_16x16x32_bf16 v[52:55], a[172:175], v[156:159], v[52:55]
    v_mfma_f32_16x16x32_bf16 v[56:59], a[144:147], v[152:155], v[56:59]
    v_exp_f32 v145, v145
    v_mfma_f32_16x16x32_bf16 v[56:59], a[176:179], v[156:159], v[56:59]
    v_cvt_pk_bf16_f32 v140, v144, v145
    v_mfma_f32_16x16x32_bf16 v[60:63], a[148:151], v[152:155], v[60:63]
    v_exp_f32 v146, v146
    v_mfma_f32_16x16x32_bf16 v[60:63], a[180:183], v[156:159], v[60:63]
    v_mfma_f32_16x16x32_bf16 v[64:67], a[152:155], v[152:155], v[64:67]
    v_exp_f32 v147, v147
    v_mfma_f32_16x16x32_bf16 v[64:67], a[184:187], v[156:159], v[64:67]
    v_cvt_pk_bf16_f32 v141, v146, v147
    v_mfma_f32_16x16x32_bf16 v[68:71], a[156:159], v[152:155], v[68:71]
    v_exp_f32 v148, v148
    v_mfma_f32_16x16x32_bf16 v[68:71], a[188:191], v[156:159], v[68:71]
    s_branch L_loop
L_slow:
    s_waitcnt vmcnt(0) lgkmcnt(0)
    s_nop 7
    v_mbcnt_lo_u32_b32 v1, -1, 0
    v_mbcnt_hi_u32_b32 v1, -1, v1
    v_and_b32 v2, 15, v1
    v_lshrrev_b32 v3, 4, v1
    v_lshlrev_b32 v2, 8, v2
    v_lshl_add_u32 v172, v3, 4, v2
    v_subrev_u32 v173, s21, v232
    v_subrev_u32 v174, s21, v233
    s_sub_u32 s3, s32, 98304
    v_add_u32 v176, s3, v220
    v_add_u32 v177, s3, v221
    v_add_u32 v178, s3, v222
    v_add_u32 v179, s3, v223
    v_add_u32 v180, s3, v224
    v_add_u32 v181, s3, v225
    v_add_u32 v182, s3, v226
    v_add_u32 v183, s3, v227
    v_mov_b32 v8, 0
    v_mov_b32 v9, 0
    v_mov_b32 v10, 0
    v_mov_b32 v11, 0
    v_mov_b32 v12, 0
    v_mov_b32 v13, 0
    v_mov_b32 v14, 0
    v_mov_b32 v15, 0
    v_mov_b32 v16, 0
    v_mov_b32 v17, 0
    v_mov_b32 v18, 0
    v_mov_b32 v19, 0
    v_mov_b32 v20, 0
    v_mov_b32 v21, 0
    v_mov_b32 v22, 0
    v_mov_b32 v23, 0
    v_mov_b32 v24, 0
    v_mov_b32 v25, 0
    v_mov_b32 v26, 0
    v_mov_b32 v27, 0
    v_mov_b32 v28, 0
    v_mov_b32 v29, 0
    v_mov_b32 v30, 0
    v_mov_b32 v31, 0
    v_mov_b32 v32, 0
    v_mov_b32 v33, 0
    v_mov_b32 v34, 0
    v_mov_b32 v35, 0
    v_mov_b32 v36, 0
    v_mov_b32 v37, 0
    v_mov_b32 v38, 0
    v_mov_b32 v39, 0
    v_mov_b32 v40, 0
    v_mov_b32 v41, 0
    v_mov_b32 v42, 0
    v_mov_b32 v43, 0
    v_mov_b32 v44, 0
    v_mov_b32 v45, 0
    v_mov_b32 v46, 0
    v_mov_b32 v47, 0
    v_mov_b32 v48, 0
    v_mov_b32 v49, 0
    v_mov_b32 v50, 0
    v_mov_b32 v51, 0
    v_mov_b32 v52, 0
    v_mov_b32 v53, 0
    v_mov_b32 v54, 0
    v_mov_b32 v55, 0
    v_mov_b32 v56, 0
    v_mov_b32 v57, 0
    v_mov_b32 v58, 0
    v_mov_b32 v59, 0
    v_mov_b32 v60, 0
    v_mov_b32 v61, 0
    v_mov_b32 v62, 0
    v_mov_b32 v63, 0
    v_mov_b32 v64, 0
    v_mov_b32 v65, 0
    v_mov_b32 v66, 0
    v_mov_b32 v67, 0
    v_mov_b32 v68, 0
    v_mov_b32 v69, 0
    v_mov_b32 v70, 0
    v_mov_b32 v71, 0
    v_mov_b32 v72, 0
    v_mov_b32 v73, 0
    v_mov_b32 v74, 0
    v_mov_b32 v75, 0
    v_mov_b32 v76, 0
    v_mov_b32 v77, 0
    v_mov_b32 v78, 0
    v_mov_b32 v79, 0
    v_mov_b32 v80, 0
    v_mov_b32 v81, 0
    v_mov_b32 v82, 0
    v_mov_b32 v83, 0
    v_mov_b32 v84, 0
    v_mov_b32 v85, 0
    v_mov_b32 v86, 0
    v_mov_b32 v87, 0
    v_mov_b32 v88, 0
    v_mov_b32 v89, 0
    v_mov_b32 v90, 0
    v_mov_b32 v91, 0
    v_mov_b32 v92, 0
    v_mov_b32 v93, 0
    v_mov_b32 v94, 0
    v_mov_b32 v95, 0
    v_mov_b32 v96, 0
    v_mov_b32 v97, 0
    v_mov_b32 v98, 0
    v_mov_b32 v99, 0
    v_mov_b32 v100, 0
    v_mov_b32 v101, 0
    v_mov_b32 v102, 0
    v_mov_b32 v103, 0
    v_mov_b32 v104, 0
    v_mov_b32 v105, 0
    v_mov_b32 v106, 0
    v_mov_b32 v107, 0
    v_mov_b32 v108, 0
    v_mov_b32 v109, 0
    v_mov_b32 v110, 0
    v_mov_b32 v111, 0
    v_mov_b32 v112, 0
    v_mov_b32 v113, 0
    v_mov_b32 v114, 0
    v_mov_b32 v115, 0
    v_mov_b32 v116, 0
    v_mov_b32 v117, 0
    v_mov_b32 v118, 0
    v_mov_b32 v119, 0
    v_mov_b32 v120, 0
    v_mov_b32 v121, 0
    v_mov_b32 v122, 0
    v_mov_b32 v123, 0
    v_mov_b32 v124, 0
    v_mov_b32 v125, 0
    v_mov_b32 v126, 0
    v_mov_b32 v127, 0
    v_mov_b32 v128, 0
    v_mov_b32 v129, 0
    v_mov_b32 v130, 0
    v_mov_b32 v131, 0
    v_mov_b32 v132, 0
    v_mov_b32 v133, 0
    v_mov_b32 v134, 0
    v_mov_b32 v135, 0
    v_mov_b32 v200, 0xff7fffff
    v_mov_b32 v204, 0
    v_mov_b32 v201, 0xff7fffff
    v_mov_b32 v205, 0
    v_mov_b32 v202, 0xff7fffff
    v_mov_b32 v206, 0
    v_mov_b32 v203, 0xff7fffff
    v_mov_b32 v207, 0
    s_mov_b32 s25, 0
L_slow_loop:
    s_mov_b32 m0, s32
    s_add_u32 s31, s25, 4096
    buffer_load_dwordx4 v173, s[12:15], s25 offen offset:0 lds
    buffer_load_dwordx4 v174, s[12:15], s25 offen offset:1024 lds
    buffer_load_dwordx4 v173, s[12:15], s25 offen offset:2048 lds
    buffer_load_dwordx4 v174, s[12:15], s25 offen offset:3072 lds
    s_add_u32 m0, s32, 4096
    s_nop 0
    buffer_load_dwordx4 v173, s[12:15], s31 offen offset:0 lds
    buffer_load_dwordx4 v174, s[12:15], s31 offen offset:1024 lds
    buffer_load_dwordx4 v173, s[12:15], s31 offen offset:2048 lds
    buffer_load_dwordx4 v174, s[12:15], s31 offen offset:3072 lds
    buffer_load_dwordx4 a[64:67], v172, s[8:11], s25 offen offset:0
    buffer_load_dwordx4 a[68:71], v172, s[8:11], s25 offen offset:64
    buffer_load_dwordx4 a[72:75], v172, s[8:11], s25 offen offset:128
    buffer_load_dwordx4 a[76:79], v172, s[8:11], s25 offen offset:192
    buffer_load_dwordx4 a[80:83], v172, s[8:11], s31 offen offset:0
    buffer_load_dwordx4 a[84:87], v172, s[8:11], s31 offen offset:64
    buffer_load_dwordx4 a[88:91], v172, s[8:11], s31 offen offset:128
    buffer_load_dwordx4 a[92:95], v172, s[8:11], s31 offen offset:192
    s_waitcnt vmcnt(0)
    v_mfma_f32_16x16x32_bf16 v[136:139], a[64:67], a[0:3], 0
    v_mfma_f32_16x16x32_bf16 v[144:147], a[64:67], a[16:19], 0
    v_mfma_f32_16x16x32_bf16 v[152:155], a[64:67], a[32:35], 0
    v_mfma_f32_16x16x32_bf16 v[160:163], a[64:67], a[48:51], 0
    v_mfma_f32_16x16x32_bf16 v[136:139], a[68:71], a[4:7], v[136:139]
    v_mfma_f32_16x16x32_bf16 v[144:147], a[68:71], a[20:23], v[144:147]
    v_mfma_f32_16x16x32_bf16 v[152:155], a[68:71], a[36:39], v[152:155]
    v_mfma_f32_16x16x32_bf16 v[160:163], a[68:71], a[52:55], v[160:163]
    v_mfma_f32_16x16x32_bf16 v[136:139], a[72:75], a[8:11], v[136:139]
    v_mfma_f32_16x16x32_bf16 v[144:147], a[72:75], a[24:27], v[144:147]
    v_mfma_f32_16x16x32_bf16 v[152:155], a[72:75], a[40:43], v[152:155]
    v_mfma_f32_16x16x32_bf16 v[160:163], a[72:75], a[56:59], v[160:163]
    v_mfma_f32_16x16x32_bf16 v[136:139], a[76:79], a[12:15], v[136:139]
    v_mfma_f32_16x16x32_bf16 v[144:147], a[76:79], a[28:31], v[144:147]
    v_mfma_f32_16x16x32_bf16 v[152:155], a[76:79], a[44:47], v[152:155]
    v_mfma_f32_16x16x32_bf16 v[160:163], a[76:79], a[60:63], v[160:163]
    v_mfma_f32_16x16x32_bf16 v[140:143], a[80:83], a[0:3], 0
    v_mfma_f32_16x16x32_bf16 v[148:151], a[80:83], a[16:19], 0
    v_mfma_f32_16x16x32_bf16 v[156:159], a[80:83], a[32:35], 0
    v_mfma_f32_16x16x32_bf16 v[164:167], a[80:83], a[48:51], 0
    v_mfma_f32_16x16x32_bf16 v[140:143], a[84:87], a[4:7], v[140:143]
    v_mfma_f32_16x16x32_bf16 v[148:151], a[84:87], a[20:23], v[148:151]
    v_mfma_f32_16x16x32_bf16 v[156:159], a[84:87], a[36:39], v[156:159]
    v_mfma_f32_16x16x32_bf16 v[164:167], a[84:87], a[52:55], v[164:167]
    v_mfma_f32_16x16x32_bf16 v[140:143], a[88:91], a[8:11], v[140:143]
    v_mfma_f32_16x16x32_bf16 v[148:151], a[88:91], a[24:27], v[148:151]
    v_mfma_f32_16x16x32_bf16 v[156:159], a[88:91], a[40:43], v[156:159]
    v_mfma_f32_16x16x32_bf16 v[164:167], a[88:91], a[56:59], v[164:167]
    v_mfma_f32_16x16x32_bf16 v[140:143], a[92:95], a[12:15], v[140:143]
    v_mfma_f32_16x16x32_bf16 v[148:151], a[92:95], a[28:31], v[148:151]
    v_mfma_f32_16x16x32_bf16 v[156:159], a[92:95], a[44:47], v[156:159]
    v_mfma_f32_16x16x32_bf16 v[164:167], a[92:95], a[60:63], v[164:167]
    ds_read_b64_tr_b16 a[128:129], v176 offset:0
    ds_read_b64_tr_b16 a[130:131], v176 offset:4096
    ds_read_b64_tr_b16 a[132:133], v177 offset:0
    ds_read_b64_tr_b16 a[134:135], v177 offset:4096
    ds_read_b64_tr_b16 a[136:137], v178 offset:0
    ds_read_b64_tr_b16 a[138:139], v178 offset:4096
    ds_read_b64_tr_b16 a[140:141], v179 offset:0
    ds_read_b64_tr_b16 a[142:143], v179 offset:4096
    ds_read_b64_tr_b16 a[144:145], v180 offset:0
    ds_read_b64_tr_b16 a[146:147], v180 offset:4096
    ds_read_b64_tr_b16 a[148:149], v181 offset:0
    ds_read_b64_tr_b16 a[150:151], v181 offset:4096
    ds_read_b64_tr_b16 a[152:153], v182 offset:0
    ds_read_b64_tr_b16 a[154:155], v182 offset:4096
    ds_read_b64_tr_b16 a[156:157], v183 offset:0
    ds_read_b64_tr_b16 a[158:159], v183 offset:4096
    v_max3_f32 v244, v200, v136, v137
    v_max3_f32 v244, v244, v138, v139
    v_max3_f32 v244, v244, v140, v141
    v_max3_f32 v244, v244, v142, v143
    v_max3_f32 v245, v201, v144, v145
    v_max3_f32 v245, v245, v146, v147
    v_max3_f32 v245, v245, v148, v149
    v_max3_f32 v245, v245, v150, v151
    v_max3_f32 v246, v202, v152, v153
    v_max3_f32 v246, v246, v154, v155
    v_max3_f32 v246, v246, v156, v157
    v_max3_f32 v246, v246, v158, v159
    v_max3_f32 v247, v203, v160, v161
    v_max3_f32 v247, v247, v162, v163
    v_max3_f32 v247, v247, v164, v165
    v_max3_f32 v247, v247, v166, v167
    v_mov_b32 v248, v244
    v_mov_b32 v249, v245
    v_mov_b32 v250, v246
    v_mov_b32 v251, v247
    v_permlane32_swap_b32 v244, v248
    v_permlane32_swap_b32 v245, v249
    v_permlane32_swap_b32 v246, v250
    v_permlane32_swap_b32 v247, v251
    v_max_f32 v244, v244, v248
    v_max_f32 v245, v245, v249
    v_max_f32 v246, v246, v250
    v_max_f32 v247, v247, v251
    v_mov_b32 v248, v244
    v_mov_b32 v249, v245
    v_mov_b32 v250, v246
    v_mov_b32 v251, v247
    v_permlane16_swap_b32 v244, v248
    v_permlane16_swap_b32 v245, v249
    v_permlane16_swap_b32 v246, v250
    v_permlane16_swap_b32 v247, v251
    v_max_f32 v244, v244, v248
    v_max_f32 v245, v245, v249
    v_max_f32 v246, v246, v250
    v_max_f32 v247, v247, v251
    v_sub_f32 v208, v200, v244
    v_sub_f32 v209, v201, v245
    v_sub_f32 v210, v202, v246
    v_sub_f32 v211, v203, v247
    v_exp_f32 v208, v208
    v_exp_f32 v209, v209
    v_exp_f32 v210, v210
    v_exp_f32 v211, v211
    v_mov_b32 v200, v244
    v_mov_b32 v201, v245
    v_mov_b32 v202, v246
    v_mov_b32 v203, v247
    v_sub_f32 v136, v136, v244
    v_sub_f32 v137, v137, v244
    v_sub_f32 v138, v138, v244
    v_sub_f32 v139, v139, v244
    v_sub_f32 v140, v140, v244
    v_sub_f32 v141, v141, v244
    v_sub_f32 v142, v142, v244
    v_sub_f32 v143, v143, v244
    v_exp_f32 v136, v136
    v_exp_f32 v137, v137
    v_exp_f32 v138, v138
    v_exp_f32 v139, v139
    v_exp_f32 v140, v140
    v_exp_f32 v141, v141
    v_exp_f32 v142, v142
    v_exp_f32 v143, v143
    v_mul_f32 v204, v204, v208
    v_add_f32 v204, v204, v136
    v_add_f32 v204, v204, v137
    v_add_f32 v204, v204, v138
    v_add_f32 v204, v204, v139
    v_add_f32 v204, v204, v140
    v_add_f32 v204, v204, v141
    v_add_f32 v204, v204, v142
    v_add_f32 v204, v204, v143
    v_cvt_pk_bf16_f32 v136, v136, v137
    v_cvt_pk_bf16_f32 v137, v138, v139
    v_cvt_pk_bf16_f32 v138, v140, v141
    v_cvt_pk_bf16_f32 v139, v142, v143
    v_mul_f32 v8, v8, v208
    v_mul_f32 v9, v9, v208
    v_mul_f32 v10, v10, v208
    v_mul_f32 v11, v11, v208
    v_mul_f32 v12, v12, v208
    v_mul_f32 v13, v13, v208
    v_mul_f32 v14, v14, v208
    v_mul_f32 v15, v15, v208
    v_mul_f32 v16, v16, v208
    v_mul_f32 v17, v17, v208
    v_mul_f32 v18, v18, v208
    v_mul_f32 v19, v19, v208
    v_mul_f32 v20, v20, v208
    v_mul_f32 v21, v21, v208
    v_mul_f32 v22, v22, v208
    v_mul_f32 v23, v23, v208
    v_mul_f32 v24, v24, v208
    v_mul_f32 v25, v25, v208
    v_mul_f32 v26, v26, v208
    v_mul_f32 v27, v27, v208
    v_mul_f32 v28, v28, v208
    v_mul_f32 v29, v29, v208
    v_mul_f32 v30, v30, v208
    v_mul_f32 v31, v31, v208
    v_mul_f32 v32, v32, v208
    v_mul_f32 v33, v33, v208
    v_mul_f32 v34, v34, v208
    v_mul_f32 v35, v35, v208
    v_mul_f32 v36, v36, v208
    v_mul_f32 v37, v37, v208
    v_mul_f32 v38, v38, v208
    v_mul_f32 v39, v39, v208
    v_sub_f32 v144, v144, v245
    v_sub_f32 v145, v145, v245
    v_sub_f32 v146, v146, v245
    v_sub_f32 v147, v147, v245
    v_sub_f32 v148, v148, v245
    v_sub_f32 v149, v149, v245
    v_sub_f32 v150, v150, v245
    v_sub_f32 v151, v151, v245
    v_exp_f32 v144, v144
    v_exp_f32 v145, v145
    v_exp_f32 v146, v146
    v_exp_f32 v147, v147
    v_exp_f32 v148, v148
    v_exp_f32 v149, v149
    v_exp_f32 v150, v150
    v_exp_f32 v151, v151
    v_mul_f32 v205, v205, v209
    v_add_f32 v205, v205, v144
    v_add_f32 v205, v205, v145
    v_add_f32 v205, v205, v146
    v_add_f32 v205, v205, v147
    v_add_f32 v205, v205, v148
    v_add_f32 v205, v205, v149
    v_add_f32 v205, v205, v150
    v_add_f32 v205, v205, v151
    v_cvt_pk_bf16_f32 v144, v144, v145
    v_cvt_pk_bf16_f32 v145, v146, v147
    v_cvt_pk_bf16_f32 v146, v148, v149
    v_cvt_pk_bf16_f32 v147, v150, v151
    v_mul_f32 v40, v40, v209
    v_mul_f32 v41, v41, v209
    v_mul_f32 v42, v42, v209
    v_mul_f32 v43, v43, v209
    v_mul_f32 v44, v44, v209
    v_mul_f32 v45, v45, v209
    v_mul_f32 v46, v46, v209
    v_mul_f32 v47, v47, v209
    v_mul_f32 v48, v48, v209
    v_mul_f32 v49, v49, v209
    v_mul_f32 v50, v50, v209
    v_mul_f32 v51, v51, v209
    v_mul_f32 v52, v52, v209
    v_mul_f32 v53, v53, v209
    v_mul_f32 v54, v54, v209
    v_mul_f32 v55, v55, v209
    v_mul_f32 v56, v56, v209
    v_mul_f32 v57, v57, v209
    v_mul_f32 v58, v58, v209
    v_mul_f32 v59, v59, v209
    v_mul_f32 v60, v60, v209
    v_mul_f32 v61, v61, v209
    v_mul_f32 v62, v62, v209
    v_mul_f32 v63, v63, v209
    v_mul_f32 v64, v64, v209
    v_mul_f32 v65, v65, v209
    v_mul_f32 v66, v66, v209
    v_mul_f32 v67, v67, v209
    v_mul_f32 v68, v68, v209
    v_mul_f32 v69, v69, v209
    v_mul_f32 v70, v70, v209
    v_mul_f32 v71, v71, v209
    v_sub_f32 v152, v152, v246
    v_sub_f32 v153, v153, v246
    v_sub_f32 v154, v154, v246
    v_sub_f32 v155, v155, v246
    v_sub_f32 v156, v156, v246
    v_sub_f32 v157, v157, v246
    v_sub_f32 v158, v158, v246
    v_sub_f32 v159, v159, v246
    v_exp_f32 v152, v152
    v_exp_f32 v153, v153
    v_exp_f32 v154, v154
    v_exp_f32 v155, v155
    v_exp_f32 v156, v156
    v_exp_f32 v157, v157
    v_exp_f32 v158, v158
    v_exp_f32 v159, v159
    v_mul_f32 v206, v206, v210
    v_add_f32 v206, v206, v152
    v_add_f32 v206, v206, v153
    v_add_f32 v206, v206, v154
    v_add_f32 v206, v206, v155
    v_add_f32 v206, v206, v156
    v_add_f32 v206, v206, v157
    v_add_f32 v206, v206, v158
    v_add_f32 v206, v206, v159
    v_cvt_pk_bf16_f32 v152, v152, v153
    v_cvt_pk_bf16_f32 v153, v154, v155
    v_cvt_pk_bf16_f32 v154, v156, v157
    v_cvt_pk_bf16_f32 v155, v158, v159
    v_mul_f32 v72, v72, v210
    v_mul_f32 v73, v73, v210
    v_mul_f32 v74, v74, v210
    v_mul_f32 v75, v75, v210
    v_mul_f32 v76, v76, v210
    v_mul_f32 v77, v77, v210
    v_mul_f32 v78, v78, v210
    v_mul_f32 v79, v79, v210
    v_mul_f32 v80, v80, v210
    v_mul_f32 v81, v81, v210
    v_mul_f32 v82, v82, v210
    v_mul_f32 v83, v83, v210
    v_mul_f32 v84, v84, v210
    v_mul_f32 v85, v85, v210
    v_mul_f32 v86, v86, v210
    v_mul_f32 v87, v87, v210
    v_mul_f32 v88, v88, v210
    v_mul_f32 v89, v89, v210
    v_mul_f32 v90, v90, v210
    v_mul_f32 v91, v91, v210
    v_mul_f32 v92, v92, v210
    v_mul_f32 v93, v93, v210
    v_mul_f32 v94, v94, v210
    v_mul_f32 v95, v95, v210
    v_mul_f32 v96, v96, v210
    v_mul_f32 v97, v97, v210
    v_mul_f32 v98, v98, v210
    v_mul_f32 v99, v99, v210
    v_mul_f32 v100, v100, v210
    v_mul_f32 v101, v101, v210
    v_mul_f32 v102, v102, v210
    v_mul_f32 v103, v103, v210
    v_sub_f32 v160, v160, v247
    v_sub_f32 v161, v161, v247
    v_sub_f32 v162, v162, v247
    v_sub_f32 v163, v163, v247
    v_sub_f32 v164, v164, v247
    v_sub_f32 v165, v165, v247
    v_sub_f32 v166, v166, v247
    v_sub_f32 v167, v167, v247
    v_exp_f32 v160, v160
    v_exp_f32 v161, v161
    v_exp_f32 v162, v162
    v_exp_f32 v163, v163
    v_exp_f32 v164, v164
    v_exp_f32 v165, v165
    v_exp_f32 v166, v166
    v_exp_f32 v167, v167
    v_mul_f32 v207, v207, v211
    v_add_f32 v207, v207, v160
    v_add_f32 v207, v207, v161
    v_add_f32 v207, v207, v162
    v_add_f32 v207, v207, v163
    v_add_f32 v207, v207, v164
    v_add_f32 v207, v207, v165
    v_add_f32 v207, v207, v166
    v_add_f32 v207, v207, v167
    v_cvt_pk_bf16_f32 v160, v160, v161
    v_cvt_pk_bf16_f32 v161, v162, v163
    v_cvt_pk_bf16_f32 v162, v164, v165
    v_cvt_pk_bf16_f32 v163, v166, v167
    v_mul_f32 v104, v104, v211
    v_mul_f32 v105, v105, v211
    v_mul_f32 v106, v106, v211
    v_mul_f32 v107, v107, v211
    v_mul_f32 v108, v108, v211
    v_mul_f32 v109, v109, v211
    v_mul_f32 v110, v110, v211
    v_mul_f32 v111, v111, v211
    v_mul_f32 v112, v112, v211
    v_mul_f32 v113, v113, v211
    v_mul_f32 v114, v114, v211
    v_mul_f32 v115, v115, v211
    v_mul_f32 v116, v116, v211
    v_mul_f32 v117, v117, v211
    v_mul_f32 v118, v118, v211
    v_mul_f32 v119, v119, v211
    v_mul_f32 v120, v120, v211
    v_mul_f32 v121, v121, v211
    v_mul_f32 v122, v122, v211
    v_mul_f32 v123, v123, v211
    v_mul_f32 v124, v124, v211
    v_mul_f32 v125, v125, v211
    v_mul_f32 v126, v126, v211
    v_mul_f32 v127, v127, v211
    v_mul_f32 v128, v128, v211
    v_mul_f32 v129, v129, v211
    v_mul_f32 v130, v130, v211
    v_mul_f32 v131, v131, v211
    v_mul_f32 v132, v132, v211
    v_mul_f32 v133, v133, v211
    v_mul_f32 v134, v134, v211
    v_mul_f32 v135, v135, v211
    s_waitcnt lgkmcnt(0)
    s_nop 1
    v_mfma_f32_16x16x32_bf16 v[8:11], a[128:131], v[136:139], v[8:11]
    v_mfma_f32_16x16x32_bf16 v[40:43], a[128:131], v[144:147], v[40:43]
    v_mfma_f32_16x16x32_bf16 v[72:75], a[128:131], v[152:155], v[72:75]
    v_mfma_f32_16x16x32_bf16 v[104:107], a[128:131], v[160:163], v[104:107]
    v_mfma_f32_16x16x32_bf16 v[12:15], a[132:135], v[136:139], v[12:15]
    v_mfma_f32_16x16x32_bf16 v[44:47], a[132:135], v[144:147], v[44:47]
    v_mfma_f32_16x16x32_bf16 v[76:79], a[132:135], v[152:155], v[76:79]
    v_mfma_f32_16x16x32_bf16 v[108:111], a[132:135], v[160:163], v[108:111]
    v_mfma_f32_16x16x32_bf16 v[16:19], a[136:139], v[136:139], v[16:19]
    v_mfma_f32_16x16x32_bf16 v[48:51], a[136:139], v[144:147], v[48:51]
    v_mfma_f32_16x16x32_bf16 v[80:83], a[136:139], v[152:155], v[80:83]
    v_mfma_f32_16x16x32_bf16 v[112:115], a[136:139], v[160:163], v[112:115]
    v_mfma_f32_16x16x32_bf16 v[20:23], a[140:143], v[136:139], v[20:23]
    v_mfma_f32_16x16x32_bf16 v[52:55], a[140:143], v[144:147], v[52:55]
    v_mfma_f32_16x16x32_bf16 v[84:87], a[140:143], v[152:155], v[84:87]
    v_mfma_f32_16x16x32_bf16 v[116:119], a[140:143], v[160:163], v[116:119]
    v_mfma_f32_16x16x32_bf16 v[24:27], a[144:147], v[136:139], v[24:27]
    v_mfma_f32_16x16x32_bf16 v[56:59], a[144:147], v[144:147], v[56:59]
    v_mfma_f32_16x16x32_bf16 v[88:91], a[144:147], v[152:155], v[88:91]
    v_mfma_f32_16x16x32_bf16 v[120:123], a[144:147], v[160:163], v[120:123]
    v_mfma_f32_16x16x32_bf16 v[28:31], a[148:151], v[136:139], v[28:31]
    v_mfma_f32_16x16x32_bf16 v[60:63], a[148:151], v[144:147], v[60:63]
    v_mfma_f32_16x16x32_bf16 v[92:95], a[148:151], v[152:155], v[92:95]
    v_mfma_f32_16x16x32_bf16 v[124:127], a[148:151], v[160:163], v[124:127]
    v_mfma_f32_16x16x32_bf16 v[32:35], a[152:155], v[136:139], v[32:35]
    v_mfma_f32_16x16x32_bf16 v[64:67], a[152:155], v[144:147], v[64:67]
    v_mfma_f32_16x16x32_bf16 v[96:99], a[152:155], v[152:155], v[96:99]
    v_mfma_f32_16x16x32_bf16 v[128:131], a[152:155], v[160:163], v[128:131]
    v_mfma_f32_16x16x32_bf16 v[36:39], a[156:159], v[136:139], v[36:39]
    v_mfma_f32_16x16x32_bf16 v[68:71], a[156:159], v[144:147], v[68:71]
    v_mfma_f32_16x16x32_bf16 v[100:103], a[156:159], v[152:155], v[100:103]
    v_mfma_f32_16x16x32_bf16 v[132:135], a[156:159], v[160:163], v[132:135]
    s_nop 7
    s_add_u32 s25, s25, 8192
    s_cmp_lt_u32 s25, 0x40000
    s_cbranch_scc1 L_slow_loop
    v_mov_b32 v244, v204
    v_mov_b32 v245, v205
    v_mov_b32 v246, v206
    v_mov_b32 v247, v207
    v_mov_b32 v248, v244
    v_mov_b32 v249, v245
    v_mov_b32 v250, v246
    v_mov_b32 v251, v247
    v_permlane32_swap_b32 v244, v248
    v_permlane32_swap_b32 v245, v249
    v_permlane32_swap_b32 v246, v250
    v_permlane32_swap_b32 v247, v251
    v_add_f32 v244, v244, v248
    v_add_f32 v245, v245, v249
    v_add_f32 v246, v246, v250
    v_add_f32 v247, v247, v251
    v_mov_b32 v248, v244
    v_mov_b32 v249, v245
    v_mov_b32 v250, v246
    v_mov_b32 v251, v247
    v_permlane16_swap_b32 v244, v248
    v_permlane16_swap_b32 v245, v249
    v_permlane16_swap_b32 v246, v250
    v_permlane16_swap_b32 v247, v251
    v_add_f32 v244, v244, v248
    v_add_f32 v245, v245, v249
    v_add_f32 v246, v246, v250
    v_add_f32 v247, v247, v251
    v_rcp_f32 v248, v244
    v_rcp_f32 v250, v245
    v_rcp_f32 v252, v246
    v_rcp_f32 v254, v247
    s_nop 0
    v_pk_mul_f32 v[8:9], v[8:9], v[248:249] op_sel_hi:[1,0]
    v_pk_mul_f32 v[10:11], v[10:11], v[248:249] op_sel_hi:[1,0]
    v_pk_mul_f32 v[12:13], v[12:13], v[248:249] op_sel_hi:[1,0]
    v_pk_mul_f32 v[14:15], v[14:15], v[248:249] op_sel_hi:[1,0]
    v_cvt_pk_bf16_f32 v8, v8, v9
    v_cvt_pk_bf16_f32 v9, v10, v11
    v_cvt_pk_bf16_f32 v10, v12, v13
    v_cvt_pk_bf16_f32 v11, v14, v15
    ds_write2_b64 v234, v[8:9], v[10:11] offset0:0 offset1:4
    v_pk_mul_f32 v[16:17], v[16:17], v[248:249] op_sel_hi:[1,0]
    v_pk_mul_f32 v[18:19], v[18:19], v[248:249] op_sel_hi:[1,0]
    v_pk_mul_f32 v[20:21], v[20:21], v[248:249] op_sel_hi:[1,0]
    v_pk_mul_f32 v[22:23], v[22:23], v[248:249] op_sel_hi:[1,0]
    v_cvt_pk_bf16_f32 v16, v16, v17
    v_cvt_pk_bf16_f32 v17, v18, v19
    v_cvt_pk_bf16_f32 v18, v20, v21
    v_cvt_pk_bf16_f32 v19, v22, v23
    ds_write2_b64 v234, v[16:17], v[18:19] offset0:8 offset1:12
    v_pk_mul_f32 v[24:25], v[24:25], v[248:249] op_sel_hi:[1,0]
    v_pk_mul_f32 v[26:27], v[26:27], v[248:249] op_sel_hi:[1,0]
    v_pk_mul_f32 v[28:29], v[28:29], v[248:249] op_sel_hi:[1,0]
    v_pk_mul_f32 v[30:31], v[30:31], v[248:249] op_sel_hi:[1,0]
    v_cvt_pk_bf16_f32 v24, v24, v25
    v_cvt_pk_bf16_f32 v25, v26, v27
    v_cvt_pk_bf16_f32 v26, v28, v29
    v_cvt_pk_bf16_f32 v27, v30, v31
    ds_write2_b64 v234, v[24:25], v[26:27] offset0:16 offset1:20
    v_pk_mul_f32 v[32:33], v[32:33], v[248:249] op_sel_hi:[1,0]
    v_pk_mul_f32 v[34:35], v[34:35], v[248:249] op_sel_hi:[1,0]
    v_pk_mul_f32 v[36:37], v[36:37], v[248:249] op_sel_hi:[1,0]
    v_pk_mul_f32 v[38:39], v[38:39], v[248:249] op_sel_hi:[1,0]
    v_cvt_pk_bf16_f32 v32, v32, v33
    v_cvt_pk_bf16_f32 v33, v34, v35
    v_cvt_pk_bf16_f32 v34, v36, v37
    v_cvt_pk_bf16_f32 v35, v38, v39
    ds_write2_b64 v234, v[32:33], v[34:35] offset0:24 offset1:28
    v_pk_mul_f32 v[40:41], v[40:41], v[250:251] op_sel_hi:[1,0]
    v_pk_mul_f32 v[42:43], v[42:43], v[250:251] op_sel_hi:[1,0]
    v_pk_mul_f32 v[44:45], v[44:45], v[250:251] op_sel_hi:[1,0]
    v_pk_mul_f32 v[46:47], v[46:47], v[250:251] op_sel_hi:[1,0]
    v_cvt_pk_bf16_f32 v40, v40, v41
    v_cvt_pk_bf16_f32 v41, v42, v43
    v_cvt_pk_bf16_f32 v42, v44, v45
    v_cvt_pk_bf16_f32 v43, v46, v47
    ds_write2_b64 v235, v[40:41], v[42:43] offset0:0 offset1:4
    v_pk_mul_f32 v[48:49], v[48:49], v[250:251] op_sel_hi:[1,0]
    v_pk_mul_f32 v[50:51], v[50:51], v[250:251] op_sel_hi:[1,0]
    v_pk_mul_f32 v[52:53], v[52:53], v[250:251] op_sel_hi:[1,0]
    v_pk_mul_f32 v[54:55], v[54:55], v[250:251] op_sel_hi:[1,0]
    v_cvt_pk_bf16_f32 v48, v48, v49
    v_cvt_pk_bf16_f32 v49, v50, v51
    v_cvt_pk_bf16_f32 v50, v52, v53
    v_cvt_pk_bf16_f32 v51, v54, v55
    ds_write2_b64 v235, v[48:49], v[50:51] offset0:8 offset1:12
    v_pk_mul_f32 v[56:57], v[56:57], v[250:251] op_sel_hi:[1,0]
    v_pk_mul_f32 v[58:59], v[58:59], v[250:251] op_sel_hi:[1,0]
    v_pk_mul_f32 v[60:61], v[60:61], v[250:251] op_sel_hi:[1,0]
    v_pk_mul_f32 v[62:63], v[62:63], v[250:251] op_sel_hi:[1,0]
    v_cvt_pk_bf16_f32 v56, v56, v57
    v_cvt_pk_bf16_f32 v57, v58, v59
    v_cvt_pk_bf16_f32 v58, v60, v61
    v_cvt_pk_bf16_f32 v59, v62, v63
    ds_write2_b64 v235, v[56:57], v[58:59] offset0:16 offset1:20
    v_pk_mul_f32 v[64:65], v[64:65], v[250:251] op_sel_hi:[1,0]
    v_pk_mul_f32 v[66:67], v[66:67], v[250:251] op_sel_hi:[1,0]
    v_pk_mul_f32 v[68:69], v[68:69], v[250:251] op_sel_hi:[1,0]
    v_pk_mul_f32 v[70:71], v[70:71], v[250:251] op_sel_hi:[1,0]
    v_cvt_pk_bf16_f32 v64, v64, v65
    v_cvt_pk_bf16_f32 v65, v66, v67
    v_cvt_pk_bf16_f32 v66, v68, v69
    v_cvt_pk_bf16_f32 v67, v70, v71
    ds_write2_b64 v235, v[64:65], v[66:67] offset0:24 offset1:28
    v_pk_mul_f32 v[72:73], v[72:73], v[252:253] op_sel_hi:[1,0]
    v_pk_mul_f32 v[74:75], v[74:75], v[252:253] op_sel_hi:[1,0]
    v_pk_mul_f32 v[76:77], v[76:77], v[252:253] op_sel_hi:[1,0]
    v_pk_mul_f32 v[78:79], v[78:79], v[252:253] op_sel_hi:[1,0]
    v_cvt_pk_bf16_f32 v72, v72, v73
    v_cvt_pk_bf16_f32 v73, v74, v75
    v_cvt_pk_bf16_f32 v74, v76, v77
    v_cvt_pk_bf16_f32 v75, v78, v79
    ds_write2_b64 v236, v[72:73], v[74:75] offset0:0 offset1:4
    v_pk_mul_f32 v[80:81], v[80:81], v[252:253] op_sel_hi:[1,0]
    v_pk_mul_f32 v[82:83], v[82:83], v[252:253] op_sel_hi:[1,0]
    v_pk_mul_f32 v[84:85], v[84:85], v[252:253] op_sel_hi:[1,0]
    v_pk_mul_f32 v[86:87], v[86:87], v[252:253] op_sel_hi:[1,0]
    v_cvt_pk_bf16_f32 v80, v80, v81
    v_cvt_pk_bf16_f32 v81, v82, v83
    v_cvt_pk_bf16_f32 v82, v84, v85
    v_cvt_pk_bf16_f32 v83, v86, v87
    ds_write2_b64 v236, v[80:81], v[82:83] offset0:8 offset1:12
    v_pk_mul_f32 v[88:89], v[88:89], v[252:253] op_sel_hi:[1,0]
    v_pk_mul_f32 v[90:91], v[90:91], v[252:253] op_sel_hi:[1,0]
    v_pk_mul_f32 v[92:93], v[92:93], v[252:253] op_sel_hi:[1,0]
    v_pk_mul_f32 v[94:95], v[94:95], v[252:253] op_sel_hi:[1,0]
    v_cvt_pk_bf16_f32 v88, v88, v89
    v_cvt_pk_bf16_f32 v89, v90, v91
    v_cvt_pk_bf16_f32 v90, v92, v93
    v_cvt_pk_bf16_f32 v91, v94, v95
    ds_write2_b64 v236, v[88:89], v[90:91] offset0:16 offset1:20
    v_pk_mul_f32 v[96:97], v[96:97], v[252:253] op_sel_hi:[1,0]
    v_pk_mul_f32 v[98:99], v[98:99], v[252:253] op_sel_hi:[1,0]
    v_pk_mul_f32 v[100:101], v[100:101], v[252:253] op_sel_hi:[1,0]
    v_pk_mul_f32 v[102:103], v[102:103], v[252:253] op_sel_hi:[1,0]
    v_cvt_pk_bf16_f32 v96, v96, v97
    v_cvt_pk_bf16_f32 v97, v98, v99
    v_cvt_pk_bf16_f32 v98, v100, v101
    v_cvt_pk_bf16_f32 v99, v102, v103
    ds_write2_b64 v236, v[96:97], v[98:99] offset0:24 offset1:28
    v_pk_mul_f32 v[104:105], v[104:105], v[254:255] op_sel_hi:[1,0]
    v_pk_mul_f32 v[106:107], v[106:107], v[254:255] op_sel_hi:[1,0]
    v_pk_mul_f32 v[108:109], v[108:109], v[254:255] op_sel_hi:[1,0]
    v_pk_mul_f32 v[110:111], v[110:111], v[254:255] op_sel_hi:[1,0]
    v_cvt_pk_bf16_f32 v104, v104, v105
    v_cvt_pk_bf16_f32 v105, v106, v107
    v_cvt_pk_bf16_f32 v106, v108, v109
    v_cvt_pk_bf16_f32 v107, v110, v111
    ds_write2_b64 v237, v[104:105], v[106:107] offset0:0 offset1:4
    v_pk_mul_f32 v[112:113], v[112:113], v[254:255] op_sel_hi:[1,0]
    v_pk_mul_f32 v[114:115], v[114:115], v[254:255] op_sel_hi:[1,0]
    v_pk_mul_f32 v[116:117], v[116:117], v[254:255] op_sel_hi:[1,0]
    v_pk_mul_f32 v[118:119], v[118:119], v[254:255] op_sel_hi:[1,0]
    v_cvt_pk_bf16_f32 v112, v112, v113
    v_cvt_pk_bf16_f32 v113, v114, v115
    v_cvt_pk_bf16_f32 v114, v116, v117
    v_cvt_pk_bf16_f32 v115, v118, v119
    ds_write2_b64 v237, v[112:113], v[114:115] offset0:8 offset1:12
    v_pk_mul_f32 v[120:121], v[120:121], v[254:255] op_sel_hi:[1,0]
    v_pk_mul_f32 v[122:123], v[122:123], v[254:255] op_sel_hi:[1,0]
    v_pk_mul_f32 v[124:125], v[124:125], v[254:255] op_sel_hi:[1,0]
    v_pk_mul_f32 v[126:127], v[126:127], v[254:255] op_sel_hi:[1,0]
    v_cvt_pk_bf16_f32 v120, v120, v121
    v_cvt_pk_bf16_f32 v121, v122, v123
    v_cvt_pk_bf16_f32 v122, v124, v125
    v_cvt_pk_bf16_f32 v123, v126, v127
    ds_write2_b64 v237, v[120:121], v[122:123] offset0:16 offset1:20
    v_pk_mul_f32 v[128:129], v[128:129], v[254:255] op_sel_hi:[1,0]
    v_pk_mul_f32 v[130:131], v[130:131], v[254:255] op_sel_hi:[1,0]
    v_pk_mul_f32 v[132:133], v[132:133], v[254:255] op_sel_hi:[1,0]
    v_pk_mul_f32 v[134:135], v[134:135], v[254:255] op_sel_hi:[1,0]
    v_cvt_pk_bf16_f32 v128, v128, v129
    v_cvt_pk_bf16_f32 v129, v130, v131
    v_cvt_pk_bf16_f32 v130, v132, v133
    v_cvt_pk_bf16_f32 v131, v134, v135
    ds_write2_b64 v237, v[128:129], v[130:131] offset0:24 offset1:28
    ds_read_b128 v[12:15], v238 offset:0
    ds_read_b128 v[20:23], v238 offset:2176
    ds_read_b128 v[28:31], v238 offset:128
    ds_read_b128 v[36:39], v238 offset:2304
    ds_read_b128 v[44:47], v238 offset:4352
    ds_read_b128 v[52:55], v238 offset:6528
    ds_read_b128 v[60:63], v238 offset:4480
    ds_read_b128 v[68:71], v238 offset:6656
    ds_read_b128 v[76:79], v238 offset:8704
    ds_read_b128 v[84:87], v238 offset:10880
    ds_read_b128 v[92:95], v238 offset:8832
    ds_read_b128 v[100:103], v238 offset:11008
    ds_read_b128 v[108:111], v238 offset:13056
    ds_read_b128 v[116:119], v238 offset:15232
    ds_read_b128 v[124:127], v238 offset:13184
    ds_read_b128 v[132:135], v238 offset:15360
    s_waitcnt lgkmcnt(0)
    buffer_store_dwordx4 v[12:15], v240, s[16:19], 0 offen offset:0 nt
    buffer_store_dwordx4 v[20:23], v240, s[16:19], 0 offen offset:2048 nt
    buffer_store_dwordx4 v[28:31], v240, s[16:19], 0 offen offset:128 nt
    buffer_store_dwordx4 v[36:39], v240, s[16:19], 0 offen offset:2176 nt
    buffer_store_dwordx4 v[44:47], v240, s[16:19], s81 offen offset:0 nt
    buffer_store_dwordx4 v[52:55], v240, s[16:19], s81 offen offset:2048 nt
    buffer_store_dwordx4 v[60:63], v240, s[16:19], s81 offen offset:128 nt
    buffer_store_dwordx4 v[68:71], v240, s[16:19], s81 offen offset:2176 nt
    buffer_store_dwordx4 v[76:79], v240, s[16:19], s82 offen offset:0 nt
    buffer_store_dwordx4 v[84:87], v240, s[16:19], s82 offen offset:2048 nt
    buffer_store_dwordx4 v[92:95], v240, s[16:19], s82 offen offset:128 nt
    buffer_store_dwordx4 v[100:103], v240, s[16:19], s82 offen offset:2176 nt
    buffer_store_dwordx4 v[108:111], v240, s[16:19], s83 offen offset:0 nt
    buffer_store_dwordx4 v[116:119], v240, s[16:19], s83 offen offset:2048 nt
    buffer_store_dwordx4 v[124:127], v240, s[16:19], s83 offen offset:128 nt
    buffer_store_dwordx4 v[132:135], v240, s[16:19], s83 offen offset:2176 nt
    s_branch L_end
.section .rodata,"a"
.p2align 6
.amdhsa_kernel standalone__gqa_softmax__near_ridge_kernel
  .amdhsa_next_free_vgpr 472
  .amdhsa_next_free_sgpr 102
  .amdhsa_accum_offset 256
  .amdhsa_group_segment_fixed_size 0
  .amdhsa_kernarg_size 48
  .amdhsa_user_sgpr_count 2
  .amdhsa_user_sgpr_kernarg_segment_ptr 1
  .amdhsa_system_sgpr_workgroup_id_x 1
  .amdhsa_float_denorm_mode_32 3
  .amdhsa_float_denorm_mode_16_64 3
.end_amdhsa_kernel
```
